```python
import torch

def _softmax(x, axis=-1):
    return torch.softmax(x, dim=axis)

def _gelu(x):
    return torch.nn.functional.gelu(x, approximate='tanh')

def _silu(x):
    return torch.nn.functional.silu(x)

def _sigmoid(x):
    return torch.sigmoid(x)

def _layernorm(x, axis=-1, eps=1e-05):
    m = x.mean(dim=axis, keepdim=True)
    v = x.var(dim=axis, keepdim=True, unbiased=False)
    return (x - m) / torch.sqrt(v + eps)

def _scatter_add(tgt, idx, src, axis=0):
    return tgt.clone().index_add_(axis, idx, src)

def _segment_sum(src, seg, n):
    out = torch.zeros((n,) + src.shape[1:], dtype=src.dtype)
    return out.index_add_(0, seg, src)

def _pad(x, pw):
    flat = tuple((v for pair in reversed(pw) for v in pair))
    return torch.nn.functional.pad(x, flat)
kernel_name = 'adaLN_cond__gqa_block_cached__glu_gated_geglu__decode'

def setup_inputs():

    _w = lambda a: (lambda t: t.to(torch.bfloat16) if t.is_floating_point() else t)(torch.as_tensor(a))

    def _A_setup():
        B, Sq, D = (1, 1, 512)
        Hq, Hkv, Sk, Dh = (32, 32, 4096, 128)
        assert Hq % Hkv == 0, (Hq, Hkv)
        return {'x': _w((lambda *s: torch.randn(*s, dtype=torch.bfloat16) * 0.05)(B, Sq, D)), 'k_cache': _w((lambda *s: torch.randn(*s, dtype=torch.bfloat16) * 3.2)(B, Hkv, Sk, Dh)), 'v_cache': _w((lambda *s: torch.randn(*s, dtype=torch.bfloat16) * 3.2)(B, Hkv, Sk, Dh)), 'wq': _w((lambda *s: torch.randn(*s, dtype=torch.bfloat16) * 3.2)(D, Hq * Dh) * D ** (-0.5)), 'wo': _w((lambda *s: torch.randn(*s, dtype=torch.bfloat16) * 3.2)(Hq * Dh, D) * (Hq * Dh) ** (-0.5))}
    _A_in = _A_setup()

    def _B_setup():
        B, S, Dm, Df = (1, 1, 512, 1376)
        return {'x': _w((lambda *s: torch.randn(*s, dtype=torch.bfloat16) * 0.05)(B, S, Dm)), 'w_gate': _w((lambda *s: torch.randn(*s, dtype=torch.bfloat16) * 3.2)(Dm, Df) * Dm ** (-0.5)), 'w_up': _w((lambda *s: torch.randn(*s, dtype=torch.bfloat16) * 3.2)(Dm, Df) * Dm ** (-0.5)), 'w_down': _w((lambda *s: torch.randn(*s, dtype=torch.bfloat16) * 3.2)(Df, Dm) * Df ** (-0.5))}
    _B_in = _B_setup()
    return {'A_x': _A_in['x'], 'A_k_cache': _A_in['k_cache'], 'A_v_cache': _A_in['v_cache'], 'A_wq': _A_in['wq'], 'A_wo': _A_in['wo'], 'B_x': _B_in['x'], 'B_w_gate': _B_in['w_gate'], 'B_w_up': _B_in['w_up'], 'B_w_down': _B_in['w_down'], 'c': _w((lambda *s: torch.randn(*s, dtype=torch.bfloat16) * 0.2)(1, 512) * 8.0), 'w_mod': _w((lambda *s: torch.randn(*s, dtype=torch.bfloat16) * 0.2)(512, 6 * 512) * 512 ** (-0.5) * 8.0)}

def reference(A_x, A_k_cache, A_v_cache, A_wq, A_wo, B_x, B_w_gate, B_w_up, B_w_down, c, w_mod):

    def _A_ref(x, k_cache, v_cache, wq, wo):
        B, Sq, D = x.shape
        Hq, Dh = (32, 128)
        Hkv = k_cache.shape[1]
        rep = Hq // Hkv
        q = (lambda x, *d: x.permute(*d))((x @ wq).reshape(B, Sq, Hq, Dh), 0, 2, 1, 3)
        k = (lambda x, n, axis: torch.repeat_interleave(x, n, dim=axis))(k_cache, rep, axis=1)
        v = (lambda x, n, axis: torch.repeat_interleave(x, n, dim=axis))(v_cache, rep, axis=1)
        scores = torch.einsum('bhqd,bhkd->bhqk', q, k) * Dh ** (-0.5)
        p = _softmax(scores, axis=-1)
        o = torch.einsum('bhqk,bhkd->bhqd', p, v)
        return (lambda x, *d: x.permute(*d))(o, 0, 2, 1, 3).reshape(B, Sq, Hq * Dh) @ wo

    def _B_ref(x, w_gate, w_up, w_down):
        g = torch.einsum('bsd,df->bsf', x, w_gate)
        u = torch.einsum('bsd,df->bsf', x, w_up)
        h = _gelu(g) * u
        return torch.einsum('bsf,fd->bsd', h, w_down)
    x = A_x
    mod = (_silu(c) @ w_mod).reshape(c.shape[0], 6, 1, -1)
    sa, ca, ga, sb, cb, gb = (mod[:, 0].clone(), mod[:, 1].clone(), mod[:, 2].clone(), mod[:, 3].clone(), mod[:, 4].clone(), mod[:, 5].clone())
    h = _layernorm(x, axis=-1) * (1 + ca) + sa
    x = x + ga * _A_ref(h, A_k_cache, A_v_cache, A_wq, A_wo)
    h = _layernorm(x, axis=-1) * (1 + cb) + sb
    x = x + gb * _B_ref(h, B_w_gate, B_w_up, B_w_down)
    return x
```

```asm
; @launch grid=(256,1,1) block=(1024,1,1) lds=142080
.amdgcn_target "amdgcn-amd-amdhsa--gfx950"
.text
.globl adaLN_cond__gqa_block_cached__glu_gated_geglu__decode_kernel
.p2align 8
.type adaLN_cond__gqa_block_cached__glu_gated_geglu__decode_kernel,@function
adaLN_cond__gqa_block_cached__glu_gated_geglu__decode_kernel:
L_code_start:
  s_load_dwordx16 s[16:31], s[0:1], 0
  s_load_dwordx8 s[32:39], s[0:1], 64
  s_load_dwordx4 s[40:43], s[0:1], 96
  s_cmp_ge_u32 s2, 256
  s_cbranch_scc1 L_end
  v_lshrrev_b32 v1, 6, v0
  v_and_b32 v0, 63, v0
  v_readfirstlane_b32 s3, v1
  s_and_b32 s4, s2, 7
  s_lshr_b32 s5, s2, 3
  s_lshr_b32 s6, s5, 3
  s_lshl_b32 s7, s4, 2
  s_add_u32 s6, s6, s7
  s_and_b32 s7, s5, 7
  s_cmp_lt_u32 s3, 8
  s_cbranch_scc1 L_R
  s_sub_u32 s9, s3, 8
  v_lshrrev_b32 v1, 4, v0
  v_and_b32 v2, 15, v0
  v_lshlrev_b32 v8, 4, v0
  s_lshl_b32 s10, s9, 14
  s_lshl_b32 s11, s6, 20
  s_lshl_b32 s12, s7, 13
  s_add_u32 s11, s11, s12
  s_lshl_b32 s12, s9, 10
  s_add_u32 s11, s11, s12
  s_mul_i32 s15, s6, 1
  s_waitcnt lgkmcnt(0)
  s_mov_b32 s44, s18
  s_mov_b32 s45, s19
  s_mov_b32 s46, 33554432
  s_mov_b32 s47, 0x20000
  s_mov_b32 s48, s20
  s_mov_b32 s49, s21
  s_mov_b32 s50, 33554432
  s_mov_b32 s51, 0x20000
  s_mov_b32 s56, s42
  s_mov_b32 s57, s43
  s_mov_b32 s58, 268435456
  s_mov_b32 s59, 0x20000
  s_add_u32 s12, s15, 0
  s_and_b32 s12, s12, 15
  s_lshl_b32 s12, s12, 16
  s_add_u32 s12, s12, s11
  s_add_u32 m0, s10, 0
  v_xor_b32 v4, 0, v8
  buffer_load_dwordx4 v4, s[44:47], s12 offen nt lds
  s_add_u32 s12, s15, 1
  s_and_b32 s12, s12, 15
  s_lshl_b32 s12, s12, 16
  s_add_u32 s12, s12, s11
  s_add_u32 m0, s10, 1024
  v_xor_b32 v5, 16, v8
  buffer_load_dwordx4 v5, s[44:47], s12 offen nt lds
  s_add_u32 s12, s15, 2
  s_and_b32 s12, s12, 15
  s_lshl_b32 s12, s12, 16
  s_add_u32 s12, s12, s11
  s_add_u32 m0, s10, 2048
  v_xor_b32 v6, 32, v8
  buffer_load_dwordx4 v6, s[44:47], s12 offen nt lds
  v_lshrrev_b32 v3, 1, v2
  v_and_b32 v13, 1, v2
  v_cmp_eq_u32 vcc, 1, v13
  v_mov_b32 v13, 0xffff
  v_mov_b32 v14, 0xffff0000
  v_cndmask_b32 v13, v13, v14, vcc
  v_cmp_eq_u32 vcc, 0, v3
  s_nop 1
  v_cndmask_b32 v9, 0, v13, vcc
  v_cmp_eq_u32 vcc, 1, v3
  s_nop 1
  v_cndmask_b32 v10, 0, v13, vcc
  v_cmp_eq_u32 vcc, 2, v3
  s_nop 1
  v_cndmask_b32 v11, 0, v13, vcc
  v_cmp_eq_u32 vcc, 3, v3
  s_nop 1
  v_cndmask_b32 v12, 0, v13, vcc
  v_xor_b32 v3, v1, v2
  v_lshlrev_b32 v17, 10, v2
  v_add_u32 v17, s10, v17
  v_xor_b32 v18, 0, v3
  v_lshl_add_u32 v13, v18, 4, v17
  v_xor_b32 v18, 4, v3
  v_lshl_add_u32 v14, v18, 4, v17
  v_xor_b32 v18, 8, v3
  v_lshl_add_u32 v15, v18, 4, v17
  v_xor_b32 v18, 12, v3
  v_lshl_add_u32 v16, v18, 4, v17
  v_lshlrev_b32 v17, 4, v1
  v_add_u32 v17, 131072, v17
  s_barrier
  s_add_u32 s12, s15, 3
  s_and_b32 s12, s12, 15
  s_lshl_b32 s12, s12, 16
  s_add_u32 s12, s12, s11
  s_add_u32 m0, s10, 3072
  v_xor_b32 v7, 48, v8
  s_waitcnt vmcnt(2)
  buffer_load_dwordx4 v7, s[44:47], s12 offen nt lds
  s_add_u32 s12, s15, 4
  s_and_b32 s12, s12, 15
  s_lshl_b32 s12, s12, 16
  s_add_u32 s12, s12, s11
  s_add_u32 m0, s10, 4096
  v_xor_b32 v4, 64, v8
  s_waitcnt vmcnt(2)
  buffer_load_dwordx4 v4, s[44:47], s12 offen nt lds
  s_add_u32 s12, s15, 5
  s_and_b32 s12, s12, 15
  s_lshl_b32 s12, s12, 16
  s_add_u32 s12, s12, s11
  s_add_u32 m0, s10, 5120
  v_xor_b32 v5, 80, v8
  s_waitcnt vmcnt(2)
  buffer_load_dwordx4 v5, s[44:47], s12 offen nt lds
  s_add_u32 s12, s15, 6
  s_and_b32 s12, s12, 15
  s_lshl_b32 s12, s12, 16
  s_add_u32 s12, s12, s11
  s_add_u32 m0, s10, 6144
  v_xor_b32 v6, 96, v8
  s_waitcnt vmcnt(2)
  buffer_load_dwordx4 v6, s[44:47], s12 offen nt lds
  s_add_u32 s12, s15, 7
  s_and_b32 s12, s12, 15
  s_lshl_b32 s12, s12, 16
  s_add_u32 s12, s12, s11
  s_add_u32 m0, s10, 7168
  v_xor_b32 v7, 112, v8
  s_waitcnt vmcnt(2)
  buffer_load_dwordx4 v7, s[44:47], s12 offen nt lds
  s_add_u32 s12, s15, 8
  s_and_b32 s12, s12, 15
  s_lshl_b32 s12, s12, 16
  s_add_u32 s12, s12, s11
  s_add_u32 m0, s10, 8192
  v_xor_b32 v4, 128, v8
  s_waitcnt vmcnt(2)
  buffer_load_dwordx4 v4, s[44:47], s12 offen nt lds
  s_add_u32 s12, s15, 9
  s_and_b32 s12, s12, 15
  s_lshl_b32 s12, s12, 16
  s_add_u32 s12, s12, s11
  s_add_u32 m0, s10, 9216
  v_xor_b32 v5, 144, v8
  s_waitcnt vmcnt(2)
  buffer_load_dwordx4 v5, s[44:47], s12 offen nt lds
  s_add_u32 s12, s15, 10
  s_and_b32 s12, s12, 15
  s_lshl_b32 s12, s12, 16
  s_add_u32 s12, s12, s11
  s_add_u32 m0, s10, 10240
  v_xor_b32 v6, 160, v8
  s_waitcnt vmcnt(2)
  buffer_load_dwordx4 v6, s[44:47], s12 offen nt lds
  s_add_u32 s12, s15, 11
  s_and_b32 s12, s12, 15
  s_lshl_b32 s12, s12, 16
  s_add_u32 s12, s12, s11
  s_add_u32 m0, s10, 11264
  v_xor_b32 v7, 176, v8
  s_waitcnt vmcnt(2)
  buffer_load_dwordx4 v7, s[44:47], s12 offen nt lds
  s_add_u32 s12, s15, 12
  s_and_b32 s12, s12, 15
  s_lshl_b32 s12, s12, 16
  s_add_u32 s12, s12, s11
  s_add_u32 m0, s10, 12288
  v_xor_b32 v4, 192, v8
  s_waitcnt vmcnt(2)
  buffer_load_dwordx4 v4, s[44:47], s12 offen nt lds
  s_add_u32 s12, s15, 13
  s_and_b32 s12, s12, 15
  s_lshl_b32 s12, s12, 16
  s_add_u32 s12, s12, s11
  s_add_u32 m0, s10, 13312
  v_xor_b32 v5, 208, v8
  s_waitcnt vmcnt(2)
  buffer_load_dwordx4 v5, s[44:47], s12 offen nt lds
  s_add_u32 s12, s15, 14
  s_and_b32 s12, s12, 15
  s_lshl_b32 s12, s12, 16
  s_add_u32 s12, s12, s11
  s_add_u32 m0, s10, 14336
  v_xor_b32 v6, 224, v8
  s_waitcnt vmcnt(2)
  buffer_load_dwordx4 v6, s[44:47], s12 offen nt lds
  s_add_u32 s12, s15, 15
  s_and_b32 s12, s12, 15
  s_lshl_b32 s12, s12, 16
  s_add_u32 s12, s12, s11
  s_add_u32 m0, s10, 15360
  v_xor_b32 v7, 240, v8
  s_waitcnt vmcnt(2)
  buffer_load_dwordx4 v7, s[44:47], s12 offen nt lds
  s_add_u32 s13, s15, 0
  s_and_b32 s13, s13, 15
  s_lshl_b32 s13, s13, 16
  s_add_u32 s13, s13, s11
  v_mov_b32 v2, 131340
  ds_read_b32 v3, v2
  s_waitcnt lgkmcnt(0)
  v_readfirstlane_b32 s14, v3
  s_cmp_lg_u32 s14, 0
  s_cbranch_scc1 L_deep_1
  s_waitcnt vmcnt(2)
  s_branch L_dj_2
L_deep_1:
  s_waitcnt vmcnt(7)
L_dj_2:
  buffer_load_dwordx4 v[64:67], v8, s[48:51], s13 offen nt
  v_mov_b32 v2, 131344
  v_mov_b32 v3, 1
  s_mov_b64 exec, 1
  ds_add_u32 v2, v3
  s_mov_b64 exec, -1
  s_add_u32 s13, s15, 1
  s_and_b32 s13, s13, 15
  s_lshl_b32 s13, s13, 16
  s_add_u32 s13, s13, s11
  v_mov_b32 v2, 131340
  ds_read_b32 v3, v2
  s_waitcnt lgkmcnt(0)
  v_readfirstlane_b32 s14, v3
  s_cmp_lg_u32 s14, 0
  s_cbranch_scc1 L_deep_3
  s_waitcnt vmcnt(2)
  s_branch L_dj_4
L_deep_3:
  s_waitcnt vmcnt(7)
L_dj_4:
  buffer_load_dwordx4 v[68:71], v8, s[48:51], s13 offen nt
  s_add_u32 s13, s15, 2
  s_and_b32 s13, s13, 15
  s_lshl_b32 s13, s13, 16
  s_add_u32 s13, s13, s11
  v_mov_b32 v2, 131340
  ds_read_b32 v3, v2
  s_waitcnt lgkmcnt(0)
  v_readfirstlane_b32 s14, v3
  s_cmp_lg_u32 s14, 0
  s_cbranch_scc1 L_deep_5
  s_waitcnt vmcnt(2)
  s_branch L_dj_6
L_deep_5:
  s_waitcnt vmcnt(7)
L_dj_6:
  buffer_load_dwordx4 v[72:75], v8, s[48:51], s13 offen nt
  s_add_u32 s13, s15, 3
  s_and_b32 s13, s13, 15
  s_lshl_b32 s13, s13, 16
  s_add_u32 s13, s13, s11
  v_mov_b32 v2, 131340
  ds_read_b32 v3, v2
  s_waitcnt lgkmcnt(0)
  v_readfirstlane_b32 s14, v3
  s_cmp_lg_u32 s14, 0
  s_cbranch_scc1 L_deep_7
  s_waitcnt vmcnt(2)
  s_branch L_dj_8
L_deep_7:
  s_waitcnt vmcnt(7)
L_dj_8:
  buffer_load_dwordx4 v[76:79], v8, s[48:51], s13 offen nt
  s_add_u32 s13, s15, 4
  s_and_b32 s13, s13, 15
  s_lshl_b32 s13, s13, 16
  s_add_u32 s13, s13, s11
  v_mov_b32 v2, 131340
  ds_read_b32 v3, v2
  s_waitcnt lgkmcnt(0)
  v_readfirstlane_b32 s14, v3
  s_cmp_lg_u32 s14, 0
  s_cbranch_scc1 L_deep_9
  s_waitcnt vmcnt(2)
  s_branch L_dj_10
L_deep_9:
  s_waitcnt vmcnt(7)
L_dj_10:
  buffer_load_dwordx4 v[80:83], v8, s[48:51], s13 offen nt
  s_add_u32 s13, s15, 5
  s_and_b32 s13, s13, 15
  s_lshl_b32 s13, s13, 16
  s_add_u32 s13, s13, s11
  v_mov_b32 v2, 131340
  ds_read_b32 v3, v2
  s_waitcnt lgkmcnt(0)
  v_readfirstlane_b32 s14, v3
  s_cmp_lg_u32 s14, 0
  s_cbranch_scc1 L_deep_11
  s_waitcnt vmcnt(2)
  s_branch L_dj_12
L_deep_11:
  s_waitcnt vmcnt(7)
L_dj_12:
  buffer_load_dwordx4 v[84:87], v8, s[48:51], s13 offen nt
  s_add_u32 s13, s15, 6
  s_and_b32 s13, s13, 15
  s_lshl_b32 s13, s13, 16
  s_add_u32 s13, s13, s11
  v_mov_b32 v2, 131340
  ds_read_b32 v3, v2
  s_waitcnt lgkmcnt(0)
  v_readfirstlane_b32 s14, v3
  s_cmp_lg_u32 s14, 0
  s_cbranch_scc1 L_deep_13
  s_waitcnt vmcnt(2)
  s_branch L_dj_14
L_deep_13:
  s_waitcnt vmcnt(7)
L_dj_14:
  buffer_load_dwordx4 v[88:91], v8, s[48:51], s13 offen nt
  s_add_u32 s13, s15, 7
  s_and_b32 s13, s13, 15
  s_lshl_b32 s13, s13, 16
  s_add_u32 s13, s13, s11
  v_mov_b32 v2, 131340
  ds_read_b32 v3, v2
  s_waitcnt lgkmcnt(0)
  v_readfirstlane_b32 s14, v3
  s_cmp_lg_u32 s14, 0
  s_cbranch_scc1 L_deep_15
  s_waitcnt vmcnt(2)
  s_branch L_dj_16
L_deep_15:
  s_waitcnt vmcnt(7)
L_dj_16:
  buffer_load_dwordx4 v[92:95], v8, s[48:51], s13 offen nt
  s_add_u32 s13, s15, 8
  s_and_b32 s13, s13, 15
  s_lshl_b32 s13, s13, 16
  s_add_u32 s13, s13, s11
  v_mov_b32 v2, 131340
  ds_read_b32 v3, v2
  s_waitcnt lgkmcnt(0)
  v_readfirstlane_b32 s14, v3
  s_cmp_lg_u32 s14, 0
  s_cbranch_scc1 L_deep_17
  s_waitcnt vmcnt(2)
  s_branch L_dj_18
L_deep_17:
  s_waitcnt vmcnt(7)
L_dj_18:
  buffer_load_dwordx4 v[96:99], v8, s[48:51], s13 offen nt
  s_add_u32 s13, s15, 9
  s_and_b32 s13, s13, 15
  s_lshl_b32 s13, s13, 16
  s_add_u32 s13, s13, s11
  v_mov_b32 v2, 131340
  ds_read_b32 v3, v2
  s_waitcnt lgkmcnt(0)
  v_readfirstlane_b32 s14, v3
  s_cmp_lg_u32 s14, 0
  s_cbranch_scc1 L_deep_19
  s_waitcnt vmcnt(2)
  s_branch L_dj_20
L_deep_19:
  s_waitcnt vmcnt(7)
L_dj_20:
  buffer_load_dwordx4 v[100:103], v8, s[48:51], s13 offen nt
  s_add_u32 s13, s15, 10
  s_and_b32 s13, s13, 15
  s_lshl_b32 s13, s13, 16
  s_add_u32 s13, s13, s11
  v_mov_b32 v2, 131340
  ds_read_b32 v3, v2
  s_waitcnt lgkmcnt(0)
  v_readfirstlane_b32 s14, v3
  s_cmp_lg_u32 s14, 0
  s_cbranch_scc1 L_deep_21
  s_waitcnt vmcnt(2)
  s_branch L_dj_22
L_deep_21:
  s_waitcnt vmcnt(7)
L_dj_22:
  buffer_load_dwordx4 v[104:107], v8, s[48:51], s13 offen nt
  s_add_u32 s13, s15, 11
  s_and_b32 s13, s13, 15
  s_lshl_b32 s13, s13, 16
  s_add_u32 s13, s13, s11
  v_mov_b32 v2, 131340
  ds_read_b32 v3, v2
  s_waitcnt lgkmcnt(0)
  v_readfirstlane_b32 s14, v3
  s_cmp_lg_u32 s14, 0
  s_cbranch_scc1 L_deep_23
  s_waitcnt vmcnt(2)
  s_branch L_dj_24
L_deep_23:
  s_waitcnt vmcnt(7)
L_dj_24:
  buffer_load_dwordx4 v[108:111], v8, s[48:51], s13 offen nt
  v_mov_b32 v2, 131340
  s_mov_b32 s14, 0
L_spin_25:
  ds_read_b32 v3, v2
  s_waitcnt lgkmcnt(0)
  v_readfirstlane_b32 s12, v3
  s_add_u32 s14, s14, 1
  s_cmp_gt_u32 s14, 200000
  s_cbranch_scc1 L_spinx_26
  s_cmp_ge_u32 s12, 1
  s_cbranch_scc1 L_spinx_26
  s_sleep 1
  s_branch L_spin_25
L_spinx_26:
  s_setprio 3
  ds_read_b128 v[20:23], v17 offset:0
  ds_read_b128 v[24:27], v17 offset:64
  ds_read_b128 v[28:31], v17 offset:128
  ds_read_b128 v[32:35], v17 offset:192
  s_waitcnt vmcnt(12)
  ds_read_b128 v[52:55], v13 offset:0
  ds_read_b128 v[56:59], v14 offset:0
  ds_read_b128 v[60:63], v15 offset:0
  ds_read_b128 v[4:7], v16 offset:0
  s_waitcnt lgkmcnt(3)
  v_mfma_f32_16x16x32_bf16 v[36:39], v[20:23], v[52:55], 0
  ds_read_b128 v[52:55], v13 offset:256
  s_waitcnt lgkmcnt(3)
  v_mfma_f32_16x16x32_bf16 v[36:39], v[24:27], v[56:59], v[36:39]
  ds_read_b128 v[56:59], v14 offset:256
  s_waitcnt lgkmcnt(3)
  v_mfma_f32_16x16x32_bf16 v[36:39], v[28:31], v[60:63], v[36:39]
  ds_read_b128 v[60:63], v15 offset:256
  s_waitcnt lgkmcnt(3)
  v_mfma_f32_16x16x32_bf16 v[36:39], v[32:35], v[4:7], v[36:39]
  ds_read_b128 v[4:7], v16 offset:256
  s_waitcnt lgkmcnt(3)
  v_mfma_f32_16x16x32_bf16 v[40:43], v[20:23], v[52:55], 0
  ds_read_b128 v[52:55], v13 offset:512
  s_waitcnt lgkmcnt(3)
  v_mfma_f32_16x16x32_bf16 v[40:43], v[24:27], v[56:59], v[40:43]
  ds_read_b128 v[56:59], v14 offset:512
  s_waitcnt lgkmcnt(3)
  v_mfma_f32_16x16x32_bf16 v[40:43], v[28:31], v[60:63], v[40:43]
  ds_read_b128 v[60:63], v15 offset:512
  s_waitcnt lgkmcnt(3)
  v_mfma_f32_16x16x32_bf16 v[40:43], v[32:35], v[4:7], v[40:43]
  ds_read_b128 v[4:7], v16 offset:512
  s_waitcnt lgkmcnt(3)
  v_mfma_f32_16x16x32_bf16 v[44:47], v[20:23], v[52:55], 0
  ds_read_b128 v[52:55], v13 offset:768
  s_waitcnt lgkmcnt(3)
  v_mfma_f32_16x16x32_bf16 v[44:47], v[24:27], v[56:59], v[44:47]
  ds_read_b128 v[56:59], v14 offset:768
  s_waitcnt lgkmcnt(3)
  v_mfma_f32_16x16x32_bf16 v[44:47], v[28:31], v[60:63], v[44:47]
  ds_read_b128 v[60:63], v15 offset:768
  s_waitcnt lgkmcnt(3)
  v_mfma_f32_16x16x32_bf16 v[44:47], v[32:35], v[4:7], v[44:47]
  ds_read_b128 v[4:7], v16 offset:768
  s_waitcnt lgkmcnt(3)
  v_mfma_f32_16x16x32_bf16 v[48:51], v[20:23], v[52:55], 0
  s_waitcnt lgkmcnt(2)
  v_mfma_f32_16x16x32_bf16 v[48:51], v[24:27], v[56:59], v[48:51]
  s_waitcnt lgkmcnt(1)
  v_mfma_f32_16x16x32_bf16 v[48:51], v[28:31], v[60:63], v[48:51]
  s_waitcnt lgkmcnt(0)
  v_mfma_f32_16x16x32_bf16 v[48:51], v[32:35], v[4:7], v[48:51]
  s_lshl_b32 s12, s9, 2
  s_add_u32 s12, s12, 131392
  v_mov_b32 v3, s12
  v_mov_b32 v2, 131348
  v_mov_b32 v17, 1
  v_mov_b32 v18, v36
  s_nop 1
  v_mov_b32_dpp v18, v40 quad_perm:[0,1,2,3] row_mask:0x2 bank_mask:0xf
  s_nop 1
  v_mov_b32_dpp v18, v44 quad_perm:[0,1,2,3] row_mask:0x4 bank_mask:0xf
  s_nop 1
  v_mov_b32_dpp v18, v48 quad_perm:[0,1,2,3] row_mask:0x8 bank_mask:0xf
  v_cvt_pk_bf16_f32 v18, v18, v18
  v_and_b32 v18, 0xffff0000, v18
  v_mul_f32 v18, 0x3db504f3, v18
  v_cvt_pk_bf16_f32 v18, v18, v18
  v_and_b32 v18, 0xffff0000, v18
  v_mov_b32 v19, v18
  s_nop 1
  v_max_f32_dpp v19, v19, v19 row_ror:8 row_mask:0xf bank_mask:0xf
  s_nop 1
  v_max_f32_dpp v19, v19, v19 row_ror:4 row_mask:0xf bank_mask:0xf
  s_nop 1
  v_max_f32_dpp v19, v19, v19 row_ror:2 row_mask:0xf bank_mask:0xf
  s_nop 1
  v_max_f32_dpp v19, v19, v19 row_ror:1 row_mask:0xf bank_mask:0xf
  s_nop 1
  v_max_f32_dpp v19, v19, v19 row_bcast:15 row_mask:0xa bank_mask:0xf
  s_nop 1
  v_max_f32_dpp v19, v19, v19 row_bcast:31 row_mask:0xc bank_mask:0xf
  s_lshl_b64 exec, 1, 63
  ds_write_b32 v3, v19
  ds_add_u32 v2, v17
  s_mov_b64 exec, -1
  s_add_u32 s13, s15, 12
  s_and_b32 s13, s13, 15
  s_lshl_b32 s13, s13, 16
  s_add_u32 s13, s13, s11
  s_waitcnt vmcnt(7)
  buffer_load_dwordx4 v[112:115], v8, s[48:51], s13 offen nt
  s_add_u32 s13, s15, 13
  s_and_b32 s13, s13, 15
  s_lshl_b32 s13, s13, 16
  s_add_u32 s13, s13, s11
  s_waitcnt vmcnt(7)
  buffer_load_dwordx4 v[116:119], v8, s[48:51], s13 offen nt
  s_add_u32 s13, s15, 14
  s_and_b32 s13, s13, 15
  s_lshl_b32 s13, s13, 16
  s_add_u32 s13, s13, s11
  s_waitcnt vmcnt(7)
  buffer_load_dwordx4 v[120:123], v8, s[48:51], s13 offen nt
  s_add_u32 s13, s15, 15
  s_and_b32 s13, s13, 15
  s_lshl_b32 s13, s13, 16
  s_add_u32 s13, s13, s11
  s_waitcnt vmcnt(7)
  buffer_load_dwordx4 v[124:127], v8, s[48:51], s13 offen nt
  v_mov_b32 v2, 131332
  v_mov_b32 v3, 1
  s_mov_b64 exec, 1
  ds_add_u32 v2, v3
  s_mov_b64 exec, -1
  v_and_b32 v36, 15, v0
  v_lshlrev_b32 v36, 5, v36
  v_lshrrev_b32 v37, 4, v0
  v_lshl_add_u32 v36, v37, 4, v36
  s_lshl_b32 s12, s9, 9
  s_add_u32 s12, s12, 131520
  v_add_u32 v36, s12, v36
  v_mov_b32 v2, 131348
  s_mov_b32 s14, 0
L_spin_27:
  ds_read_b32 v3, v2
  s_waitcnt lgkmcnt(0)
  v_readfirstlane_b32 s12, v3
  s_add_u32 s14, s14, 1
  s_cmp_gt_u32 s14, 200000
  s_cbranch_scc1 L_spinx_28
  s_cmp_ge_u32 s12, 8
  s_cbranch_scc1 L_spinx_28
  s_sleep 0
  s_branch L_spin_27
L_spinx_28:
  v_mov_b32 v2, 131392
  ds_read_b128 v[20:23], v2
  ds_read_b128 v[24:27], v2 offset:16
  s_lshl_b32 s12, s9, 2
  s_add_u32 s12, s12, 131424
  v_mov_b32 v3, s12
  s_waitcnt lgkmcnt(0)
  v_max3_f32 v20, v20, v21, v22
  v_max3_f32 v24, v24, v25, v26
  v_max3_f32 v20, v20, v23, v27
  v_max_f32 v19, v20, v24
  v_sub_f32 v18, v18, v19
  v_mul_f32 v18, 0x3fb8aa3b, v18
  v_exp_f32 v18, v18
  s_nop 0
  v_cvt_pk_bf16_f32 v20, v18, v18
  s_nop 1
  v_and_b32_dpp v24, v20, v9 row_newbcast:0 row_mask:0xf bank_mask:0xf
  v_and_b32_dpp v25, v20, v10 row_newbcast:0 row_mask:0xf bank_mask:0xf
  v_and_b32_dpp v26, v20, v11 row_newbcast:0 row_mask:0xf bank_mask:0xf
  v_and_b32_dpp v27, v20, v12 row_newbcast:0 row_mask:0xf bank_mask:0xf
  s_waitcnt vmcnt(15)
  s_nop 0
  v_mfma_f32_16x16x32_bf16 v[32:35], v[24:27], v[64:67], 0
  v_add_f32_dpp v18, v18, v18 row_ror:8 row_mask:0xf bank_mask:0xf
  s_nop 1
  v_add_f32_dpp v18, v18, v18 row_ror:4 row_mask:0xf bank_mask:0xf
  s_nop 1
  v_add_f32_dpp v18, v18, v18 row_ror:2 row_mask:0xf bank_mask:0xf
  s_nop 1
  v_add_f32_dpp v18, v18, v18 row_ror:1 row_mask:0xf bank_mask:0xf
  s_nop 1
  v_add_f32_dpp v18, v18, v18 row_bcast:15 row_mask:0xa bank_mask:0xf
  s_nop 1
  v_add_f32_dpp v18, v18, v18 row_bcast:31 row_mask:0xc bank_mask:0xf
  s_lshl_b64 exec, 1, 63
  ds_write_b32 v3, v18
  s_mov_b64 exec, -1
  v_and_b32_dpp v28, v20, v9 row_newbcast:1 row_mask:0xf bank_mask:0xf
  v_and_b32_dpp v29, v20, v10 row_newbcast:1 row_mask:0xf bank_mask:0xf
  v_and_b32_dpp v30, v20, v11 row_newbcast:1 row_mask:0xf bank_mask:0xf
  v_and_b32_dpp v31, v20, v12 row_newbcast:1 row_mask:0xf bank_mask:0xf
  s_waitcnt vmcnt(14)
  s_nop 0
  v_mfma_f32_16x16x32_bf16 v[32:35], v[28:31], v[68:71], v[32:35]
  v_and_b32_dpp v24, v20, v9 row_newbcast:2 row_mask:0xf bank_mask:0xf
  v_and_b32_dpp v25, v20, v10 row_newbcast:2 row_mask:0xf bank_mask:0xf
  v_and_b32_dpp v26, v20, v11 row_newbcast:2 row_mask:0xf bank_mask:0xf
  v_and_b32_dpp v27, v20, v12 row_newbcast:2 row_mask:0xf bank_mask:0xf
  s_waitcnt vmcnt(13)
  s_nop 0
  v_mfma_f32_16x16x32_bf16 v[32:35], v[24:27], v[72:75], v[32:35]
  v_and_b32_dpp v28, v20, v9 row_newbcast:3 row_mask:0xf bank_mask:0xf
  v_and_b32_dpp v29, v20, v10 row_newbcast:3 row_mask:0xf bank_mask:0xf
  v_and_b32_dpp v30, v20, v11 row_newbcast:3 row_mask:0xf bank_mask:0xf
  v_and_b32_dpp v31, v20, v12 row_newbcast:3 row_mask:0xf bank_mask:0xf
  s_waitcnt vmcnt(12)
  s_nop 0
  v_mfma_f32_16x16x32_bf16 v[32:35], v[28:31], v[76:79], v[32:35]
  v_and_b32_dpp v24, v20, v9 row_newbcast:4 row_mask:0xf bank_mask:0xf
  v_and_b32_dpp v25, v20, v10 row_newbcast:4 row_mask:0xf bank_mask:0xf
  v_and_b32_dpp v26, v20, v11 row_newbcast:4 row_mask:0xf bank_mask:0xf
  v_and_b32_dpp v27, v20, v12 row_newbcast:4 row_mask:0xf bank_mask:0xf
  s_waitcnt vmcnt(11)
  s_nop 0
  v_mfma_f32_16x16x32_bf16 v[32:35], v[24:27], v[80:83], v[32:35]
  v_and_b32_dpp v28, v20, v9 row_newbcast:5 row_mask:0xf bank_mask:0xf
  v_and_b32_dpp v29, v20, v10 row_newbcast:5 row_mask:0xf bank_mask:0xf
  v_and_b32_dpp v30, v20, v11 row_newbcast:5 row_mask:0xf bank_mask:0xf
  v_and_b32_dpp v31, v20, v12 row_newbcast:5 row_mask:0xf bank_mask:0xf
  s_waitcnt vmcnt(10)
  s_nop 0
  v_mfma_f32_16x16x32_bf16 v[32:35], v[28:31], v[84:87], v[32:35]
  v_and_b32_dpp v24, v20, v9 row_newbcast:6 row_mask:0xf bank_mask:0xf
  v_and_b32_dpp v25, v20, v10 row_newbcast:6 row_mask:0xf bank_mask:0xf
  v_and_b32_dpp v26, v20, v11 row_newbcast:6 row_mask:0xf bank_mask:0xf
  v_and_b32_dpp v27, v20, v12 row_newbcast:6 row_mask:0xf bank_mask:0xf
  s_waitcnt vmcnt(9)
  s_nop 0
  v_mfma_f32_16x16x32_bf16 v[32:35], v[24:27], v[88:91], v[32:35]
  v_and_b32_dpp v28, v20, v9 row_newbcast:7 row_mask:0xf bank_mask:0xf
  v_and_b32_dpp v29, v20, v10 row_newbcast:7 row_mask:0xf bank_mask:0xf
  v_and_b32_dpp v30, v20, v11 row_newbcast:7 row_mask:0xf bank_mask:0xf
  v_and_b32_dpp v31, v20, v12 row_newbcast:7 row_mask:0xf bank_mask:0xf
  s_waitcnt vmcnt(8)
  s_nop 0
  v_mfma_f32_16x16x32_bf16 v[32:35], v[28:31], v[92:95], v[32:35]
  v_and_b32_dpp v24, v20, v9 row_newbcast:8 row_mask:0xf bank_mask:0xf
  v_and_b32_dpp v25, v20, v10 row_newbcast:8 row_mask:0xf bank_mask:0xf
  v_and_b32_dpp v26, v20, v11 row_newbcast:8 row_mask:0xf bank_mask:0xf
  v_and_b32_dpp v27, v20, v12 row_newbcast:8 row_mask:0xf bank_mask:0xf
  s_waitcnt vmcnt(7)
  s_nop 0
  v_mfma_f32_16x16x32_bf16 v[32:35], v[24:27], v[96:99], v[32:35]
  v_and_b32_dpp v28, v20, v9 row_newbcast:9 row_mask:0xf bank_mask:0xf
  v_and_b32_dpp v29, v20, v10 row_newbcast:9 row_mask:0xf bank_mask:0xf
  v_and_b32_dpp v30, v20, v11 row_newbcast:9 row_mask:0xf bank_mask:0xf
  v_and_b32_dpp v31, v20, v12 row_newbcast:9 row_mask:0xf bank_mask:0xf
  s_waitcnt vmcnt(6)
  s_nop 0
  v_mfma_f32_16x16x32_bf16 v[32:35], v[28:31], v[100:103], v[32:35]
  v_and_b32_dpp v24, v20, v9 row_newbcast:10 row_mask:0xf bank_mask:0xf
  v_and_b32_dpp v25, v20, v10 row_newbcast:10 row_mask:0xf bank_mask:0xf
  v_and_b32_dpp v26, v20, v11 row_newbcast:10 row_mask:0xf bank_mask:0xf
  v_and_b32_dpp v27, v20, v12 row_newbcast:10 row_mask:0xf bank_mask:0xf
  s_waitcnt vmcnt(5)
  s_nop 0
  v_mfma_f32_16x16x32_bf16 v[32:35], v[24:27], v[104:107], v[32:35]
  v_and_b32_dpp v28, v20, v9 row_newbcast:11 row_mask:0xf bank_mask:0xf
  v_and_b32_dpp v29, v20, v10 row_newbcast:11 row_mask:0xf bank_mask:0xf
  v_and_b32_dpp v30, v20, v11 row_newbcast:11 row_mask:0xf bank_mask:0xf
  v_and_b32_dpp v31, v20, v12 row_newbcast:11 row_mask:0xf bank_mask:0xf
  s_waitcnt vmcnt(4)
  s_nop 0
  v_mfma_f32_16x16x32_bf16 v[32:35], v[28:31], v[108:111], v[32:35]
  v_and_b32_dpp v24, v20, v9 row_newbcast:12 row_mask:0xf bank_mask:0xf
  v_and_b32_dpp v25, v20, v10 row_newbcast:12 row_mask:0xf bank_mask:0xf
  v_and_b32_dpp v26, v20, v11 row_newbcast:12 row_mask:0xf bank_mask:0xf
  v_and_b32_dpp v27, v20, v12 row_newbcast:12 row_mask:0xf bank_mask:0xf
  s_waitcnt vmcnt(3)
  s_nop 0
  v_mfma_f32_16x16x32_bf16 v[32:35], v[24:27], v[112:115], v[32:35]
  v_and_b32_dpp v28, v20, v9 row_newbcast:13 row_mask:0xf bank_mask:0xf
  v_and_b32_dpp v29, v20, v10 row_newbcast:13 row_mask:0xf bank_mask:0xf
  v_and_b32_dpp v30, v20, v11 row_newbcast:13 row_mask:0xf bank_mask:0xf
  v_and_b32_dpp v31, v20, v12 row_newbcast:13 row_mask:0xf bank_mask:0xf
  s_waitcnt vmcnt(2)
  s_nop 0
  v_mfma_f32_16x16x32_bf16 v[32:35], v[28:31], v[116:119], v[32:35]
  v_and_b32_dpp v24, v20, v9 row_newbcast:14 row_mask:0xf bank_mask:0xf
  v_and_b32_dpp v25, v20, v10 row_newbcast:14 row_mask:0xf bank_mask:0xf
  v_and_b32_dpp v26, v20, v11 row_newbcast:14 row_mask:0xf bank_mask:0xf
  v_and_b32_dpp v27, v20, v12 row_newbcast:14 row_mask:0xf bank_mask:0xf
  s_waitcnt vmcnt(1)
  s_nop 0
  v_mfma_f32_16x16x32_bf16 v[32:35], v[24:27], v[120:123], v[32:35]
  v_and_b32_dpp v28, v20, v9 row_newbcast:15 row_mask:0xf bank_mask:0xf
  v_and_b32_dpp v29, v20, v10 row_newbcast:15 row_mask:0xf bank_mask:0xf
  v_and_b32_dpp v30, v20, v11 row_newbcast:15 row_mask:0xf bank_mask:0xf
  v_and_b32_dpp v31, v20, v12 row_newbcast:15 row_mask:0xf bank_mask:0xf
  s_waitcnt vmcnt(0)
  s_nop 0
  v_mfma_f32_16x16x32_bf16 v[32:35], v[28:31], v[124:127], v[32:35]
  v_mov_b32 v2, 131352
  v_mov_b32 v3, 1
  v_lshlrev_b32 v37, 3, v0
  v_add_u32 v38, 131520, v37
  s_lshl_b32 s12, s6, 3
  s_add_u32 s12, s12, s7
  s_mul_i32 s13, s12, 528
  s_add_u32 s13, s13, 393216
  v_mov_b32 v39, 131424
  v_mov_b32 v40, 512
  s_mov_b32 exec_lo, -1
  s_mov_b32 exec_hi, 0
  ds_write_b128 v36, v[32:35]
  s_mov_b64 exec, 1
  ds_add_rtn_u32 v3, v2, v3
  s_waitcnt lgkmcnt(0)
  v_readfirstlane_b32 s12, v3
  s_mov_b64 exec, -1
  s_cmp_eq_u32 s12, 7
  s_cbranch_scc1 L_dopub_30
  s_mov_b64 exec, 0
  s_branch SEG_SP_0
WRET_SP_0:
  s_mov_b64 exec, -1
  s_branch L_nopub_29
L_dopub_30:
SEG_SP_0:
PAD_SP_0:
  s_cbranch_execz PAD_SP_1
  ds_read_b64 v[48:49], v38 offset:0
  ds_read_b64 v[50:51], v38 offset:512
  ds_read_b64 v[52:53], v38 offset:1024
  ds_read_b64 v[54:55], v38 offset:1536
  ds_read_b64 v[56:57], v38 offset:2048
  ds_read_b64 v[58:59], v38 offset:2560
  ds_read_b64 v[60:61], v38 offset:3072
PAD_SP_1:
  s_cbranch_execz PAD_SP_2
  ds_read_b64 v[62:63], v38 offset:3584
  ds_read_b128 v[24:27], v39
  ds_read_b128 v[28:31], v39 offset:16
  v_mov_b32 v2, 131356
  ds_read_b32 v3, v2
  ds_read_b32 v41, v2 offset:8
  s_and_b32 s14, s6, 3
  s_lshl_b32 s14, s14, 3
  s_add_u32 s14, s14, s7
PAD_SP_2:
  s_cbranch_execz PAD_SP_3
  s_lshl_b32 s14, s14, 2
  s_lshl_b32 s12, s4, 7
  s_add_u32 s14, s14, s12
  s_add_u32 s14, s14, 7168
  v_mov_b32 v42, s14
  s_waitcnt lgkmcnt(4)
  v_pk_add_f32 v[48:49], v[48:49], v[50:51]
  v_pk_add_f32 v[52:53], v[52:53], v[54:55]
  v_pk_add_f32 v[56:57], v[56:57], v[58:59]
  v_pk_add_f32 v[60:61], v[60:61], v[62:63]
PAD_SP_3:
  s_cbranch_execz PAD_SP_4
  v_pk_add_f32 v[48:49], v[48:49], v[52:53]
  v_pk_add_f32 v[56:57], v[56:57], v[60:61]
  v_pk_add_f32 v[48:49], v[48:49], v[56:57]
  s_waitcnt lgkmcnt(0)
  v_readfirstlane_b32 s12, v3
  v_add_f32 v24, v24, v25
  v_add_f32 v26, v26, v27
  v_add_f32 v28, v28, v29
  v_add_f32 v30, v30, v31
  v_add_f32 v24, v24, v26
  v_add_f32 v28, v28, v30
  v_add_f32 v24, v24, v28
PAD_SP_4:
  s_cbranch_execz PAD_SP_5
  v_min_u32 v48, -2, v48
  v_min_u32 v49, -2, v49
  v_min_u32 v25, -2, v24
  v_min_u32 v24, -2, v19
  s_cmp_eq_u32 s12, 0
  s_cbranch_scc1 L_oslow_31
  buffer_store_dwordx2 v[48:49], v37, s[56:59], s13 offen
  s_mov_b64 exec, 1
  buffer_store_dwordx2 v[24:25], v40, s[56:59], s13 offen
  s_branch L_opub_32
L_oslow_31:
  buffer_store_dwordx2 v[48:49], v37, s[56:59], s13 offen sc1
  s_mov_b64 exec, 1
PAD_SP_5:
  s_cbranch_execz PAD_SP_6
  buffer_store_dwordx2 v[24:25], v40, s[56:59], s13 offen sc1
L_opub_32:
  v_mov_b32 v2, 131360
  v_mov_b32 v3, 1
  ds_write_b32 v2, v3
  s_mov_b64 exec, -1
L_nopub_29:
PAD_SP_6:
  s_cbranch_execz WRET_SP_0
  s_endpgm
L_R:
  s_setprio 3
  s_lshl_b32 s8, s5, 3
  s_add_u32 s8, s8, s4
  s_and_b32 s11, s8, 3
  s_lshl_b32 s11, s11, 7
  s_lshl_b32 s12, s3, 4
  s_add_u32 s11, s11, s12
  v_lshrrev_b32 v6, 3, v0
  v_lshlrev_b32 v6, 1, v6
  v_add_u32 v6, s11, v6
  v_mul_u32_u24 v5, 6144, v6
  v_and_b32 v7, 7, v0
  v_lshl_add_u32 v5, v7, 4, v5
  s_lshr_b32 s12, s8, 2
  s_lshl_b32 s12, s12, 7
  v_add_u32 v5, s12, v5
  v_and_b32 v7, 1, v0
  v_add_u32 v6, v6, v7
  v_lshlrev_b32 v6, 1, v6
  v_lshlrev_b32 v4, 4, v0
  s_waitcnt lgkmcnt(0)
  s_mov_b32 s52, s36
  s_mov_b32 s53, s37
  s_mov_b32 s54, 3145728
  s_mov_b32 s55, 0x20000
  s_mov_b32 s48, s34
  s_mov_b32 s49, s35
  s_mov_b32 s50, 1024
  s_mov_b32 s51, 0x20000
  s_cmp_ge_u32 s5, 24
  s_cbranch_scc1 L_nomodld_33
  buffer_load_dwordx4 v[32:35], v5, s[52:55], 0 offen nt
  s_mov_b32 s12, 6144
  buffer_load_dwordx4 v[36:39], v5, s[52:55], s12 offen nt
  buffer_load_ushort v28, v6, s[48:51], 0 offen
L_nomodld_33:
  s_cmp_lg_u32 s3, 0
  s_cbranch_scc1 L_notw0_34
  v_mov_b32 v16, 0
  v_lshlrev_b32 v14, 2, v0
  v_add_u32 v14, 131328, v14
  s_mov_b64 exec, 0xffff
  ds_write_b32 v14, v16
  s_mov_b64 exec, -1
  s_waitcnt lgkmcnt(0)
L_notw0_34:
  s_barrier
  s_load_dword s15, s[42:43], 0
  s_mov_b32 s26, s16
  s_mov_b32 s27, s17
  s_mov_b32 s44, s16
  s_mov_b32 s45, s17
  s_mov_b32 s46, 1024
  s_mov_b32 s47, 0x20000
  s_mov_b32 s60, s22
  s_mov_b32 s61, s23
  s_mov_b32 s62, 4194304
  s_mov_b32 s63, 0x20000
  s_mov_b32 s56, s42
  s_mov_b32 s57, s43
  s_mov_b32 s58, 268435456
  s_mov_b32 s59, 0x20000
  v_lshrrev_b32 v1, 4, v0
  v_and_b32 v2, 15, v0
  s_cmp_lg_u32 s3, 1
  s_cbranch_scc1 L_noqld_35
  s_lshl_b32 s12, s7, 6
  v_add_u32 v8, s12, v0
  v_lshlrev_b32 v3, 1, v8
  v_lshlrev_b32 v7, 17, v1
  v_lshl_add_u32 v7, v2, 4, v7
  buffer_load_dwordx4 v[24:27], v4, s[44:47], 0 offen
  buffer_load_ushort v29, v3, s[44:47], 0 offen
  s_lshl_b32 s12, s7, 19
  s_lshl_b32 s13, s6, 8
  s_add_u32 s12, s12, s13
  buffer_load_dwordx4 v[64:67], v7, s[60:63], s12 offen nt
  s_add_u32 s12, s12, 8192
  buffer_load_dwordx4 v[68:71], v7, s[60:63], s12 offen nt
  s_add_u32 s12, s12, 8192
  buffer_load_dwordx4 v[72:75], v7, s[60:63], s12 offen nt
  s_add_u32 s12, s12, 8192
  buffer_load_dwordx4 v[76:79], v7, s[60:63], s12 offen nt
  s_add_u32 s12, s12, 8192
  buffer_load_dwordx4 v[80:83], v7, s[60:63], s12 offen nt
  s_add_u32 s12, s12, 8192
  buffer_load_dwordx4 v[84:87], v7, s[60:63], s12 offen nt
  s_add_u32 s12, s12, 8192
  buffer_load_dwordx4 v[88:91], v7, s[60:63], s12 offen nt
  s_add_u32 s12, s12, 8192
  buffer_load_dwordx4 v[92:95], v7, s[60:63], s12 offen nt
  s_add_u32 s12, s12, 8192
  buffer_load_dwordx4 v[96:99], v7, s[60:63], s12 offen nt
  s_add_u32 s12, s12, 8192
  buffer_load_dwordx4 v[100:103], v7, s[60:63], s12 offen nt
  s_add_u32 s12, s12, 8192
  buffer_load_dwordx4 v[104:107], v7, s[60:63], s12 offen nt
  s_add_u32 s12, s12, 8192
  buffer_load_dwordx4 v[108:111], v7, s[60:63], s12 offen nt
  s_add_u32 s12, s12, 8192
  buffer_load_dwordx4 v[112:115], v7, s[60:63], s12 offen nt
  s_add_u32 s12, s12, 8192
  buffer_load_dwordx4 v[116:119], v7, s[60:63], s12 offen nt
  s_add_u32 s12, s12, 8192
  buffer_load_dwordx4 v[120:123], v7, s[60:63], s12 offen nt
  s_add_u32 s12, s12, 8192
  buffer_load_dwordx4 v[124:127], v7, s[60:63], s12 offen nt
L_noqld_35:
  s_mov_b32 s72, s32
  s_mov_b32 s73, s33
  s_mov_b32 s74, 1409024
  s_mov_b32 s75, 0x20000
  s_mov_b32 s76, s38
  s_mov_b32 s77, s39
  s_mov_b32 s78, 1024
  s_mov_b32 s79, 0x20000
  s_mov_b32 s36, s24
  s_mov_b32 s37, s25
  s_mov_b32 s38, 4194304
  s_mov_b32 s39, 0x20000
  s_mov_b32 s64, s40
  s_mov_b32 s65, s41
  s_mov_b32 s66, 256
  s_mov_b32 s67, 0x20000
  s_sub_u32 s12, s5, 16
  s_mul_i32 s10, s4, 6
  s_add_u32 s10, s10, s12
  s_cmp_lt_u32 s12, 6
  s_cselect_b32 s10, s10, 0xffff
  v_bfe_u32 v3, v2, 1, 2
  v_and_b32 v13, 1, v2
  v_cmp_eq_u32 vcc, 1, v13
  v_mov_b32 v13, 0xffff
  v_mov_b32 v14, 0xffff0000
  v_cndmask_b32 v13, v13, v14, vcc
  v_cmp_eq_u32 vcc, 0, v3
  s_nop 1
  v_cndmask_b32 v9, 0, v13, vcc
  v_cmp_eq_u32 vcc, 1, v3
  s_nop 1
  v_cndmask_b32 v10, 0, v13, vcc
  v_cmp_eq_u32 vcc, 2, v3
  s_nop 1
  v_cndmask_b32 v11, 0, v13, vcc
  v_cmp_eq_u32 vcc, 3, v3
  s_nop 1
  v_cndmask_b32 v12, 0, v13, vcc
  v_and_b32 v30, 7, v0
  v_lshlrev_b32 v30, 8, v30
  v_bfe_u32 v3, v0, 4, 1
  v_lshl_add_u32 v30, v3, 7, v30
  s_lshl_b32 s12, s3, 2
  s_add_u32 s12, s12, 137664
  v_add_u32 v30, s12, v30
  s_waitcnt lgkmcnt(0)
  s_mul_i32 s15, s15, 1664525
  s_add_u32 s15, s15, 1013904223
  s_cmp_lg_u32 s3, 2
  s_cbranch_scc1 L_noxi_36
  s_lshl_b32 s12, s6, 3
  s_add_u32 s12, s12, s7
  s_lshl_b32 s12, s12, 2
  s_add_u32 s12, s12, 6144
  s_getreg_b32 s13, hwreg(HW_REG_XCC_ID, 0, 3)
  s_andn2_b32 s16, s15, 7
  s_or_b32 s13, s13, s16
  v_mov_b32 v18, s13
  v_mov_b32 v19, 0
  s_mov_b64 exec, 1
  buffer_store_dword v18, v19, s[56:59], s12 offen sc1
  s_mov_b64 exec, -1
L_noxi_36:
  s_cmp_ge_u32 s5, 24
  s_cbranch_scc1 L_nomod_37
  s_cmp_eq_u32 s3, 1
  s_cbranch_scc1 L_mw1_38
  s_cmp_eq_u32 s3, 2
  s_cbranch_scc1 L_mw3_40
  s_waitcnt vmcnt(0)
  s_branch L_mw2_39
L_mw3_40:
  s_waitcnt vmcnt(1)
  s_branch L_mw2_39
L_mw1_38:
  s_waitcnt vmcnt(18)
L_mw2_39:
  v_lshlrev_b32 v28, 16, v28
  v_mul_f32 v18, 0x3fb8aa3b, v28
  v_exp_f32 v18, -v18
  s_nop 0
  v_add_f32 v18, 1.0, v18
  v_rcp_f32 v18, v18
  s_nop 0
  v_mul_f32 v18, v28, v18
  v_cvt_pk_bf16_f32 v18, v18, v18
  s_nop 1
  v_and_b32_dpp v14, v18, v9 quad_perm:[0,0,0,0] row_mask:0xf bank_mask:0xf
  v_and_b32_dpp v15, v18, v10 quad_perm:[0,0,0,0] row_mask:0xf bank_mask:0xf
  v_and_b32_dpp v16, v18, v11 quad_perm:[0,0,0,0] row_mask:0xf bank_mask:0xf
  v_and_b32_dpp v17, v18, v12 quad_perm:[0,0,0,0] row_mask:0xf bank_mask:0xf
  s_nop 1
  v_mfma_f32_16x16x32_bf16 v[20:23], v[14:17], v[32:35], 0
  v_and_b32_dpp v40, v18, v9 quad_perm:[1,1,1,1] row_mask:0xf bank_mask:0xf
  v_and_b32_dpp v41, v18, v10 quad_perm:[1,1,1,1] row_mask:0xf bank_mask:0xf
  v_and_b32_dpp v42, v18, v11 quad_perm:[1,1,1,1] row_mask:0xf bank_mask:0xf
  v_and_b32_dpp v43, v18, v12 quad_perm:[1,1,1,1] row_mask:0xf bank_mask:0xf
  s_nop 1
  v_mfma_f32_16x16x32_bf16 v[20:23], v[40:43], v[36:39], v[20:23]
  s_lshr_b32 s12, s8, 2
  s_lshl_b32 s12, s12, 9
  s_and_b32 s13, s8, 3
  s_mul_i32 s13, s13, 24576
  s_add_u32 s12, s12, s13
  s_add_u32 s16, s12, 917504
  s_nop 1
  v_mov_b32 v44, v20
  v_mov_b32 v45, v21
  v_mov_b32 v46, v22
  v_mov_b32 v47, v23
  v_permlane32_swap_b32 v20, v44
  v_permlane32_swap_b32 v21, v45
  v_permlane32_swap_b32 v22, v46
  v_permlane32_swap_b32 v23, v47
  v_add_f32_dpp v20, v44, v20 row_ror:8 row_mask:0xf bank_mask:0xf
  v_add_f32_dpp v21, v45, v21 row_ror:8 row_mask:0xf bank_mask:0xf
  v_add_f32_dpp v22, v46, v22 row_ror:8 row_mask:0xf bank_mask:0xf
  v_add_f32_dpp v23, v47, v23 row_ror:8 row_mask:0xf bank_mask:0xf
  s_mov_b32 exec_lo, 0x00ff00ff
  s_mov_b32 exec_hi, 0
  ds_write_b32 v30, v20 offset:0
  ds_write_b32 v30, v21 offset:32
  ds_write_b32 v30, v22 offset:64
  ds_write_b32 v30, v23 offset:96
  s_mov_b64 exec, -1
  v_mov_b32 v30, 131328
  v_mov_b32 v18, 1
  s_mov_b64 exec, 1
  ds_add_rtn_u32 v18, v30, v18
  s_waitcnt lgkmcnt(0)
  v_readfirstlane_b32 s12, v18
  s_mov_b64 exec, -1
  s_cmp_lg_u32 s12, 7
  s_cbranch_scc1 L_nomod_37
  v_lshlrev_b32 v30, 5, v0
  v_add_u32 v30, 137664, v30
  ds_read_b128 v[44:47], v30
  ds_read_b128 v[48:51], v30 offset:16
  v_lshlrev_b32 v30, 3, v0
  v_mov_b32 v21, s15
  s_waitcnt lgkmcnt(0)
  v_add_f32 v44, v44, v45
  v_add_f32 v46, v46, v47
  v_add_f32 v48, v48, v49
  v_add_f32 v50, v50, v51
  v_add_f32 v44, v44, v46
  v_add_f32 v48, v48, v50
  v_add_f32 v44, v44, v48
  v_mov_b32 v20, v44
  v_mov_b32 v23, s15
  v_mov_b32_dpp v22, v44 quad_perm:[1,1,3,3] row_mask:0xf bank_mask:0xf
  s_mov_b32 exec_lo, 0x55555555
  s_mov_b32 exec_hi, 0x55555555
  buffer_store_dwordx4 v[20:23], v30, s[56:59], s16 offen sc1
  s_mov_b64 exec, -1
L_nomod_37:
  s_cmp_lg_u32 s3, 0
  s_cbranch_scc1 L_noflag_41
  v_mov_b32 v20, -1
  v_mov_b32 v21, -1
  v_mov_b32 v22, -1
  v_mov_b32 v23, -1
  s_lshl_b32 s12, s6, 3
  s_add_u32 s12, s12, s7
  s_mul_i32 s12, s12, 528
  s_add_u32 s12, s12, 393216
  s_mov_b32 exec_lo, -1
  s_mov_b32 exec_hi, 1
  buffer_store_dwordx4 v[20:23], v4, s[56:59], s12 offen sc1
  s_mov_b64 exec, -1
  s_cmp_lt_u32 s5, 16
  s_cbranch_scc1 L_noAPclr_42
  s_sub_u32 s13, s5, 16
  s_lshl_b32 s13, s13, 8
  s_lshl_b32 s12, s4, 12
  s_add_u32 s12, s12, s13
  s_add_u32 s12, s12, 589824
  s_mov_b64 exec, 0xffff
  buffer_store_dwordx4 v[20:23], v4, s[56:59], s12 offen sc1
  s_mov_b64 exec, -1
L_noAPclr_42:
  s_cmp_ge_u32 s10, 43
  s_cbranch_scc1 L_noDPclr_43
  v_lshrrev_b32 v16, 2, v0
  v_mul_u32_u24 v16, 3072, v16
  v_and_b32 v17, 3, v0
  v_lshl_add_u32 v16, v17, 4, v16
  s_lshl_b32 s12, s10, 6
  s_add_u32 s12, s12, 655360
  buffer_store_dwordx4 v[20:23], v16, s[56:59], s12 offen sc1
  s_add_u32 s12, s12, 49152
  buffer_store_dwordx4 v[20:23], v16, s[56:59], s12 offen sc1
L_noDPclr_43:
  s_waitcnt vmcnt(0)
  s_lshl_b32 s12, s6, 3
  s_add_u32 s12, s12, s7
  s_lshl_b32 s12, s12, 2
  s_add_u32 s12, s12, 4096
  v_mov_b32 v18, s15
  v_mov_b32 v19, 0
  s_mov_b64 exec, 1
  buffer_store_dword v18, v19, s[56:59], s12 offen sc1
  s_mov_b64 exec, -1
L_noflag_41:
  s_cmp_lg_u32 s3, 2
  s_cbranch_scc1 L_nofin_44
  s_sub_u32 s12, s8, 64
  s_cmp_ge_u32 s12, 64
  s_cbranch_scc1 L_nofin_44
  s_lshl_b32 s13, s12, 8
  s_add_u32 s16, s13, 925696
  s_add_u32 s17, s13, 851968
  v_mul_u32_u24 v18, 24576, v1
  v_lshl_add_u32 v18, v2, 3, v18
  s_mov_b32 s14, 0
L_pollFin_45:
  buffer_load_dwordx2 v[32:33], v18, s[56:59], s16 offen sc1
  buffer_load_dwordx2 v[34:35], v18, s[56:59], s16 offen offset:128 sc1
  s_add_u32 s14, s14, 1
  s_cmp_gt_u32 s14, 200000
  s_cbranch_scc1 L_pollFinx_46
  s_waitcnt vmcnt(0)
  v_xor_b32 v20, s15, v33
  v_xor_b32 v21, s15, v35
  v_or_b32 v20, v20, v21
  v_cmp_ne_u32 vcc, 0, v20
  s_cbranch_vccz L_pollFinx_46
  s_sleep 16
  s_branch L_pollFin_45
L_pollFinx_46:
  s_waitcnt vmcnt(0)
  v_permlane32_swap_b32 v32, v34
  v_add_f32 v32, v32, v34
  v_mov_b32 v20, v32
  s_nop 1
  v_permlane16_swap_b32 v32, v20
  v_add_f32 v32, v32, v20
  v_cvt_pk_bf16_f32 v32, v32, v32
  v_and_b32 v32, 0xffff0000, v32
  v_mov_b32 v33, s15
  v_lshrrev_b32 v18, 5, v0
  v_lshlrev_b32 v18, 4, v18
  v_add_u32 v18, v18, v2
  v_lshlrev_b32 v18, 3, v18
  s_mov_b32 exec_lo, 0xffff
  s_mov_b32 exec_hi, 0xffff
  buffer_store_dwordx2 v[32:33], v18, s[56:59], s17 offen sc1
  s_mov_b64 exec, -1
L_nofin_44:
  s_cmp_lg_u32 s3, 1
  s_cbranch_scc1 L_noq_48
  s_waitcnt vmcnt(16)
  v_lshlrev_b32 v32, 16, v24
  v_and_b32 v33, 0xffff0000, v24
  v_lshlrev_b32 v34, 16, v25
  v_and_b32 v35, 0xffff0000, v25
  v_lshlrev_b32 v36, 16, v26
  v_and_b32 v37, 0xffff0000, v26
  v_lshlrev_b32 v38, 16, v27
  v_and_b32 v39, 0xffff0000, v27
  v_add_f32 v40, v32, v33
  v_add_f32 v40, v40, v34
  v_add_f32 v40, v40, v35
  v_add_f32 v40, v40, v36
  v_add_f32 v40, v40, v37
  v_add_f32 v40, v40, v38
  v_add_f32 v40, v40, v39
  s_nop 1
  v_add_f32_dpp v40, v40, v40 row_ror:8 row_mask:0xf bank_mask:0xf
  s_nop 1
  v_add_f32_dpp v40, v40, v40 row_ror:4 row_mask:0xf bank_mask:0xf
  s_nop 1
  v_add_f32_dpp v40, v40, v40 row_ror:2 row_mask:0xf bank_mask:0xf
  s_nop 1
  v_add_f32_dpp v40, v40, v40 row_ror:1 row_mask:0xf bank_mask:0xf
  s_nop 1
  v_add_f32_dpp v40, v40, v40 row_bcast:15 row_mask:0xa bank_mask:0xf
  s_nop 1
  v_add_f32_dpp v40, v40, v40 row_bcast:31 row_mask:0xc bank_mask:0xf
  s_nop 0
  v_readlane_b32 s20, v40, 63
  s_nop 1
  v_mov_b32 v40, s20
  v_mul_f32 v40, 0x3b000000, v40
  v_sub_f32 v41, v32, v40
  v_mul_f32 v17, v41, v41
  v_sub_f32 v41, v33, v40
  v_fmac_f32 v17, v41, v41
  v_sub_f32 v41, v34, v40
  v_fmac_f32 v17, v41, v41
  v_sub_f32 v41, v35, v40
  v_fmac_f32 v17, v41, v41
  v_sub_f32 v41, v36, v40
  v_fmac_f32 v17, v41, v41
  v_sub_f32 v41, v37, v40
  v_fmac_f32 v17, v41, v41
  v_sub_f32 v41, v38, v40
  v_fmac_f32 v17, v41, v41
  v_sub_f32 v41, v39, v40
  v_fmac_f32 v17, v41, v41
  s_nop 1
  v_add_f32_dpp v17, v17, v17 row_ror:8 row_mask:0xf bank_mask:0xf
  s_nop 1
  v_add_f32_dpp v17, v17, v17 row_ror:4 row_mask:0xf bank_mask:0xf
  s_nop 1
  v_add_f32_dpp v17, v17, v17 row_ror:2 row_mask:0xf bank_mask:0xf
  s_nop 1
  v_add_f32_dpp v17, v17, v17 row_ror:1 row_mask:0xf bank_mask:0xf
  s_nop 1
  v_add_f32_dpp v17, v17, v17 row_bcast:15 row_mask:0xa bank_mask:0xf
  s_nop 1
  v_add_f32_dpp v17, v17, v17 row_bcast:31 row_mask:0xc bank_mask:0xf
  s_nop 0
  v_readlane_b32 s20, v17, 63
  s_nop 1
  v_mov_b32 v17, s20
  v_mul_f32 v17, 0x3b000000, v17
  v_cvt_pk_bf16_f32 v16, v40, v40
  v_and_b32 v16, 0xffff0000, v16
  v_cvt_pk_bf16_f32 v17, v17, v17
  v_and_b32 v17, 0xffff0000, v17
  v_add_f32 v17, 0x3727c5ac, v17
  v_cvt_pk_bf16_f32 v17, v17, v17
  v_and_b32 v17, 0xffff0000, v17
  v_sqrt_f32 v17, v17
  s_nop 0
  v_cvt_pk_bf16_f32 v17, v17, v17
  v_and_b32 v17, 0xffff0000, v17
  v_lshrrev_b32 v3, 1, v2
  v_and_b32 v13, 1, v2
  v_cmp_eq_u32 vcc, 1, v13
  v_mov_b32 v13, 0xffff
  v_mov_b32 v14, 0xffff0000
  v_cndmask_b32 v13, v13, v14, vcc
  v_cmp_eq_u32 vcc, 0, v3
  s_nop 1
  v_cndmask_b32 v52, 0, v13, vcc
  v_cmp_eq_u32 vcc, 1, v3
  s_nop 1
  v_cndmask_b32 v53, 0, v13, vcc
  v_cmp_eq_u32 vcc, 2, v3
  s_nop 1
  v_cndmask_b32 v54, 0, v13, vcc
  v_cmp_eq_u32 vcc, 3, v3
  s_nop 1
  v_cndmask_b32 v55, 0, v13, vcc
  v_lshlrev_b32 v18, 3, v8
  v_add_u32 v18, 917504, v18
  v_rcp_f32 v23, v17
  v_and_b32 v31, 31, v0
  v_lshlrev_b32 v30, 2, v31
  s_lshl_b32 s12, s4, 7
  s_add_u32 s12, s12, 6144
  v_add_u32 v30, s12, v30
  s_getreg_b32 s20, hwreg(HW_REG_XCC_ID, 0, 3)
  v_lshlrev_b32 v29, 16, v29
  v_sub_f32 v29, v29, v16
  v_cvt_pk_bf16_f32 v29, v29, v29
  v_and_b32 v29, 0xffff0000, v29
  v_mul_f32 v19, v29, v23
  v_fma_f32 v22, -v19, v17, v29
  v_fma_f32 v29, v22, v23, v19
  v_cvt_pk_bf16_f32 v29, v29, v29
  v_and_b32 v29, 0xffff0000, v29
  v_lshlrev_b32 v24, 6, v2
  v_lshl_add_u32 v24, v1, 5, v24
  s_lshl_b32 s12, s6, 3
  s_add_u32 s13, s12, s7
  s_lshl_b32 s13, s13, 10
  s_add_u32 s17, s13, 65536
  s_lshl_b32 s12, s12, 10
  s_add_u32 s18, s12, 65536
  s_add_u32 s19, s18, 4096
  v_mov_b32 v45, s15
  v_mov_b32 v47, s15
  v_mov_b32 v49, s15
  v_mov_b32 v51, s15
  v_lshlrev_b32 v25, 2, v0
  v_add_u32 v25, 131072, v25
  v_mov_b32 v26, 131340
  v_mov_b32 v27, 1
  s_sleep 25
  s_mov_b32 s14, 0
L_poll1_49:
  s_mov_b32 s13, 0
  buffer_load_dwordx2 v[32:33], v18, s[56:59], s13 offen sc1
  s_mov_b32 s13, 4096
  buffer_load_dwordx2 v[34:35], v18, s[56:59], s13 offen sc1
  s_mov_b32 s13, 24576
  buffer_load_dwordx2 v[38:39], v18, s[56:59], s13 offen sc1
  s_mov_b32 s13, 28672
  buffer_load_dwordx2 v[40:41], v18, s[56:59], s13 offen sc1
  s_mov_b32 s13, 49152
  buffer_load_dwordx2 v[42:43], v18, s[56:59], s13 offen sc1
  s_mov_b32 s13, 53248
  buffer_load_dwordx2 v[56:57], v18, s[56:59], s13 offen sc1
  s_mov_b32 s13, 73728
  buffer_load_dwordx2 v[58:59], v18, s[56:59], s13 offen sc1
  s_mov_b32 s13, 77824
  buffer_load_dwordx2 v[60:61], v18, s[56:59], s13 offen sc1
  buffer_load_dword v36, v30, s[56:59], 0 offen sc1
  s_add_u32 s14, s14, 1
  s_cmp_gt_u32 s14, 200000
  s_cbranch_scc1 L_poll1x_50
  s_waitcnt vmcnt(0)
  v_xor_b32 v20, s15, v33
  v_xor_b32 v21, s15, v35
  v_or_b32 v20, v20, v21
  v_xor_b32 v21, s15, v39
  v_or_b32 v20, v20, v21
  v_xor_b32 v21, s15, v41
  v_or_b32 v20, v20, v21
  v_xor_b32 v21, s15, v43
  v_or_b32 v20, v20, v21
  v_xor_b32 v21, s15, v57
  v_or_b32 v20, v20, v21
  v_xor_b32 v21, s15, v59
  v_or_b32 v20, v20, v21
  v_xor_b32 v21, s15, v61
  v_or_b32 v20, v20, v21
  v_xor_b32 v21, s15, v36
  v_and_b32 v21, -8, v21
  v_or_b32 v20, v20, v21
  v_cmp_ne_u32 vcc, 0, v20
  s_cbranch_vccz L_poll1x_50
  s_sleep 12
  s_branch L_poll1_49
L_poll1x_50:
  s_waitcnt vmcnt(0)
  v_and_b32 v36, 7, v36
  v_cmp_ne_u32 vcc, s20, v36
  s_nop 4
  s_and_b32 s12, s6, 3
  s_lshl_b32 s12, s12, 3
  s_lshr_b32 s12, vcc_lo, s12
  s_and_b32 s12, s12, 0xff
  s_cmp_eq_u32 s12, 0
  s_cselect_b32 s25, 1, 0
  s_cmp_eq_u32 vcc_lo, 0
  s_cselect_b32 s13, 1, 0
  v_mov_b32 v30, 131356
  v_mov_b32 v31, s13
  s_mov_b64 exec, 1
  ds_write_b32 v30, v31
  v_mov_b32 v30, 131364
  v_mov_b32 v31, s15
  ds_write_b32 v30, v31
  s_mov_b64 exec, -1
  v_add_f32 v32, v32, v38
  v_add_f32 v34, v34, v40
  v_add_f32 v42, v42, v58
  v_add_f32 v56, v56, v60
  v_add_f32 v32, v32, v42
  v_add_f32 v34, v34, v56
  v_cvt_pk_bf16_f32 v32, v32, v32
  v_and_b32 v32, 0xffff0000, v32
  v_cvt_pk_bf16_f32 v34, v34, v34
  v_and_b32 v34, 0xffff0000, v34
  v_add_f32 v34, 1.0, v34
  v_cvt_pk_bf16_f32 v34, v34, v34
  v_and_b32 v34, 0xffff0000, v34
  v_mul_f32 v19, v29, v34
  v_cvt_pk_bf16_f32 v19, v19, v19
  v_and_b32 v19, 0xffff0000, v19
  v_add_f32 v19, v19, v32
  v_cvt_pk_bf16_f32 v19, v19, v19
  s_nop 1
  v_and_b32_dpp v32, v19, v52 row_newbcast:0 row_mask:0xf bank_mask:0xf
  v_and_b32_dpp v33, v19, v53 row_newbcast:0 row_mask:0xf bank_mask:0xf
  v_and_b32_dpp v34, v19, v54 row_newbcast:0 row_mask:0xf bank_mask:0xf
  v_and_b32_dpp v35, v19, v55 row_newbcast:0 row_mask:0xf bank_mask:0xf
  v_and_b32_dpp v36, v19, v52 row_newbcast:1 row_mask:0xf bank_mask:0xf
  v_and_b32_dpp v37, v19, v53 row_newbcast:1 row_mask:0xf bank_mask:0xf
  v_and_b32_dpp v38, v19, v54 row_newbcast:1 row_mask:0xf bank_mask:0xf
  v_and_b32_dpp v39, v19, v55 row_newbcast:1 row_mask:0xf bank_mask:0xf
  v_mfma_f32_16x16x32_bf16 v[40:43], v[32:35], v[64:67], 0
  v_and_b32_dpp v56, v19, v52 row_newbcast:2 row_mask:0xf bank_mask:0xf
  v_and_b32_dpp v57, v19, v53 row_newbcast:2 row_mask:0xf bank_mask:0xf
  v_and_b32_dpp v58, v19, v54 row_newbcast:2 row_mask:0xf bank_mask:0xf
  v_and_b32_dpp v59, v19, v55 row_newbcast:2 row_mask:0xf bank_mask:0xf
  v_mfma_f32_16x16x32_bf16 v[40:43], v[36:39], v[68:71], v[40:43]
  v_and_b32_dpp v32, v19, v52 row_newbcast:3 row_mask:0xf bank_mask:0xf
  v_and_b32_dpp v33, v19, v53 row_newbcast:3 row_mask:0xf bank_mask:0xf
  v_and_b32_dpp v34, v19, v54 row_newbcast:3 row_mask:0xf bank_mask:0xf
  v_and_b32_dpp v35, v19, v55 row_newbcast:3 row_mask:0xf bank_mask:0xf
  v_mfma_f32_16x16x32_bf16 v[40:43], v[56:59], v[72:75], v[40:43]
  v_and_b32_dpp v36, v19, v52 row_newbcast:4 row_mask:0xf bank_mask:0xf
  v_and_b32_dpp v37, v19, v53 row_newbcast:4 row_mask:0xf bank_mask:0xf
  v_and_b32_dpp v38, v19, v54 row_newbcast:4 row_mask:0xf bank_mask:0xf
  v_and_b32_dpp v39, v19, v55 row_newbcast:4 row_mask:0xf bank_mask:0xf
  v_mfma_f32_16x16x32_bf16 v[40:43], v[32:35], v[76:79], v[40:43]
  v_and_b32_dpp v56, v19, v52 row_newbcast:5 row_mask:0xf bank_mask:0xf
  v_and_b32_dpp v57, v19, v53 row_newbcast:5 row_mask:0xf bank_mask:0xf
  v_and_b32_dpp v58, v19, v54 row_newbcast:5 row_mask:0xf bank_mask:0xf
  v_and_b32_dpp v59, v19, v55 row_newbcast:5 row_mask:0xf bank_mask:0xf
  v_mfma_f32_16x16x32_bf16 v[40:43], v[36:39], v[80:83], v[40:43]
  v_and_b32_dpp v32, v19, v52 row_newbcast:6 row_mask:0xf bank_mask:0xf
  v_and_b32_dpp v33, v19, v53 row_newbcast:6 row_mask:0xf bank_mask:0xf
  v_and_b32_dpp v34, v19, v54 row_newbcast:6 row_mask:0xf bank_mask:0xf
  v_and_b32_dpp v35, v19, v55 row_newbcast:6 row_mask:0xf bank_mask:0xf
  v_mfma_f32_16x16x32_bf16 v[40:43], v[56:59], v[84:87], v[40:43]
  v_and_b32_dpp v36, v19, v52 row_newbcast:7 row_mask:0xf bank_mask:0xf
  v_and_b32_dpp v37, v19, v53 row_newbcast:7 row_mask:0xf bank_mask:0xf
  v_and_b32_dpp v38, v19, v54 row_newbcast:7 row_mask:0xf bank_mask:0xf
  v_and_b32_dpp v39, v19, v55 row_newbcast:7 row_mask:0xf bank_mask:0xf
  v_mfma_f32_16x16x32_bf16 v[40:43], v[32:35], v[88:91], v[40:43]
  v_and_b32_dpp v56, v19, v52 row_newbcast:8 row_mask:0xf bank_mask:0xf
  v_and_b32_dpp v57, v19, v53 row_newbcast:8 row_mask:0xf bank_mask:0xf
  v_and_b32_dpp v58, v19, v54 row_newbcast:8 row_mask:0xf bank_mask:0xf
  v_and_b32_dpp v59, v19, v55 row_newbcast:8 row_mask:0xf bank_mask:0xf
  v_mfma_f32_16x16x32_bf16 v[40:43], v[36:39], v[92:95], v[40:43]
  v_and_b32_dpp v32, v19, v52 row_newbcast:9 row_mask:0xf bank_mask:0xf
  v_and_b32_dpp v33, v19, v53 row_newbcast:9 row_mask:0xf bank_mask:0xf
  v_and_b32_dpp v34, v19, v54 row_newbcast:9 row_mask:0xf bank_mask:0xf
  v_and_b32_dpp v35, v19, v55 row_newbcast:9 row_mask:0xf bank_mask:0xf
  v_mfma_f32_16x16x32_bf16 v[40:43], v[56:59], v[96:99], v[40:43]
  v_and_b32_dpp v36, v19, v52 row_newbcast:10 row_mask:0xf bank_mask:0xf
  v_and_b32_dpp v37, v19, v53 row_newbcast:10 row_mask:0xf bank_mask:0xf
  v_and_b32_dpp v38, v19, v54 row_newbcast:10 row_mask:0xf bank_mask:0xf
  v_and_b32_dpp v39, v19, v55 row_newbcast:10 row_mask:0xf bank_mask:0xf
  v_mfma_f32_16x16x32_bf16 v[40:43], v[32:35], v[100:103], v[40:43]
  v_and_b32_dpp v56, v19, v52 row_newbcast:11 row_mask:0xf bank_mask:0xf
  v_and_b32_dpp v57, v19, v53 row_newbcast:11 row_mask:0xf bank_mask:0xf
  v_and_b32_dpp v58, v19, v54 row_newbcast:11 row_mask:0xf bank_mask:0xf
  v_and_b32_dpp v59, v19, v55 row_newbcast:11 row_mask:0xf bank_mask:0xf
  v_mfma_f32_16x16x32_bf16 v[40:43], v[36:39], v[104:107], v[40:43]
  v_and_b32_dpp v32, v19, v52 row_newbcast:12 row_mask:0xf bank_mask:0xf
  v_and_b32_dpp v33, v19, v53 row_newbcast:12 row_mask:0xf bank_mask:0xf
  v_and_b32_dpp v34, v19, v54 row_newbcast:12 row_mask:0xf bank_mask:0xf
  v_and_b32_dpp v35, v19, v55 row_newbcast:12 row_mask:0xf bank_mask:0xf
  v_mfma_f32_16x16x32_bf16 v[40:43], v[56:59], v[108:111], v[40:43]
  v_and_b32_dpp v36, v19, v52 row_newbcast:13 row_mask:0xf bank_mask:0xf
  v_and_b32_dpp v37, v19, v53 row_newbcast:13 row_mask:0xf bank_mask:0xf
  v_and_b32_dpp v38, v19, v54 row_newbcast:13 row_mask:0xf bank_mask:0xf
  v_and_b32_dpp v39, v19, v55 row_newbcast:13 row_mask:0xf bank_mask:0xf
  v_mfma_f32_16x16x32_bf16 v[40:43], v[32:35], v[112:115], v[40:43]
  v_and_b32_dpp v56, v19, v52 row_newbcast:14 row_mask:0xf bank_mask:0xf
  v_and_b32_dpp v57, v19, v53 row_newbcast:14 row_mask:0xf bank_mask:0xf
  v_and_b32_dpp v58, v19, v54 row_newbcast:14 row_mask:0xf bank_mask:0xf
  v_and_b32_dpp v59, v19, v55 row_newbcast:14 row_mask:0xf bank_mask:0xf
  v_mfma_f32_16x16x32_bf16 v[40:43], v[36:39], v[116:119], v[40:43]
  v_and_b32_dpp v32, v19, v52 row_newbcast:15 row_mask:0xf bank_mask:0xf
  v_and_b32_dpp v33, v19, v53 row_newbcast:15 row_mask:0xf bank_mask:0xf
  v_and_b32_dpp v34, v19, v54 row_newbcast:15 row_mask:0xf bank_mask:0xf
  v_and_b32_dpp v35, v19, v55 row_newbcast:15 row_mask:0xf bank_mask:0xf
  v_mfma_f32_16x16x32_bf16 v[40:43], v[56:59], v[120:123], v[40:43]
  s_nop 0
  v_mfma_f32_16x16x32_bf16 v[40:43], v[32:35], v[124:127], v[40:43]
  s_nop 7
  v_mov_b32 v44, v40
  v_mov_b32 v46, v41
  v_mov_b32 v48, v42
  v_mov_b32 v50, v43
  s_mov_b32 exec_lo, -1
  s_mov_b32 exec_hi, 0
  s_cmp_eq_u32 s25, 0
  s_cbranch_scc1 L_qslow_52
  buffer_store_dwordx4 v[44:47], v24, s[56:59], s17 offen
  buffer_store_dwordx4 v[48:51], v24, s[56:59], s17 offen offset:16
  s_branch L_qjoin_53
L_qslow_52:
  buffer_store_dwordx4 v[44:47], v24, s[56:59], s17 offen sc1
  buffer_store_dwordx4 v[48:51], v24, s[56:59], s17 offen offset:16 sc1
L_qjoin_53:
  s_mov_b64 exec, -1
  s_mov_b32 s14, 0
  s_mov_b32 s9, 15
L_poll2_54:
  s_bitcmp1_b32 s9, 0
  s_cbranch_scc0 L_poll2s_56
  buffer_load_dwordx4 v[64:67], v4, s[56:59], s18 offen offset:0 sc1
  buffer_load_dwordx4 v[68:71], v4, s[56:59], s18 offen offset:1024 sc1
L_poll2s_56:
  s_bitcmp1_b32 s9, 1
  s_cbranch_scc0 L_poll2s_57
  buffer_load_dwordx4 v[72:75], v4, s[56:59], s18 offen offset:2048 sc1
  buffer_load_dwordx4 v[76:79], v4, s[56:59], s18 offen offset:3072 sc1
L_poll2s_57:
  s_bitcmp1_b32 s9, 2
  s_cbranch_scc0 L_poll2s_58
  buffer_load_dwordx4 v[80:83], v4, s[56:59], s19 offen offset:0 sc1
  buffer_load_dwordx4 v[84:87], v4, s[56:59], s19 offen offset:1024 sc1
L_poll2s_58:
  s_bitcmp1_b32 s9, 3
  s_cbranch_scc0 L_poll2s_59
  buffer_load_dwordx4 v[88:91], v4, s[56:59], s19 offen offset:2048 sc1
  buffer_load_dwordx4 v[92:95], v4, s[56:59], s19 offen offset:3072 sc1
L_poll2s_59:
  s_add_u32 s14, s14, 1
  s_cmp_gt_u32 s14, 200000
  s_cbranch_scc1 L_poll2x_55
  s_waitcnt vmcnt(0)
  s_bitcmp1_b32 s9, 0
  s_cbranch_scc0 L_poll2c_60
  v_xor_b32 v20, s15, v65
  v_xor_b32 v21, s15, v67
  v_or_b32 v20, v20, v21
  v_xor_b32 v21, s15, v69
  v_or_b32 v20, v20, v21
  v_xor_b32 v21, s15, v71
  v_or_b32 v20, v20, v21
  v_cmp_ne_u32 vcc, 0, v20
  s_cbranch_vccnz L_poll2c_60
  s_bitset0_b32 s9, 0
L_poll2c_60:
  s_bitcmp1_b32 s9, 1
  s_cbranch_scc0 L_poll2c_61
  v_xor_b32 v20, s15, v73
  v_xor_b32 v21, s15, v75
  v_or_b32 v20, v20, v21
  v_xor_b32 v21, s15, v77
  v_or_b32 v20, v20, v21
  v_xor_b32 v21, s15, v79
  v_or_b32 v20, v20, v21
  v_cmp_ne_u32 vcc, 0, v20
  s_cbranch_vccnz L_poll2c_61
  s_bitset0_b32 s9, 1
L_poll2c_61:
  s_bitcmp1_b32 s9, 2
  s_cbranch_scc0 L_poll2c_62
  v_xor_b32 v20, s15, v81
  v_xor_b32 v21, s15, v83
  v_or_b32 v20, v20, v21
  v_xor_b32 v21, s15, v85
  v_or_b32 v20, v20, v21
  v_xor_b32 v21, s15, v87
  v_or_b32 v20, v20, v21
  v_cmp_ne_u32 vcc, 0, v20
  s_cbranch_vccnz L_poll2c_62
  s_bitset0_b32 s9, 2
L_poll2c_62:
  s_bitcmp1_b32 s9, 3
  s_cbranch_scc0 L_poll2c_63
  v_xor_b32 v20, s15, v89
  v_xor_b32 v21, s15, v91
  v_or_b32 v20, v20, v21
  v_xor_b32 v21, s15, v93
  v_or_b32 v20, v20, v21
  v_xor_b32 v21, s15, v95
  v_or_b32 v20, v20, v21
  v_cmp_ne_u32 vcc, 0, v20
  s_cbranch_vccnz L_poll2c_63
  s_bitset0_b32 s9, 3
L_poll2c_63:
  s_cmp_eq_u32 s9, 0
  s_cbranch_scc1 L_poll2x_55
  s_sleep 2
  s_branch L_poll2_54
L_poll2x_55:
  s_waitcnt vmcnt(0)
  v_add_f32 v64, v64, v68
  v_add_f32 v72, v72, v76
  v_add_f32 v80, v80, v84
  v_add_f32 v88, v88, v92
  v_add_f32 v64, v64, v72
  v_add_f32 v80, v80, v88
  v_add_f32 v64, v64, v80
  v_add_f32 v66, v66, v70
  v_add_f32 v74, v74, v78
  v_add_f32 v82, v82, v86
  v_add_f32 v90, v90, v94
  v_add_f32 v66, v66, v74
  v_add_f32 v82, v82, v90
  v_add_f32 v66, v66, v82
  v_cvt_pk_bf16_f32 v19, v64, v66
  ds_write_b32 v25, v19
  s_mov_b64 exec, 1
  ds_write_b32 v26, v27
  s_mov_b64 exec, -1
L_noq_48:
  v_mov_b32 v17, 131344
  s_mov_b32 s14, 0
L_spin_67:
  ds_read_b32 v18, v17
  s_waitcnt lgkmcnt(0)
  v_readfirstlane_b32 s12, v18
  s_add_u32 s14, s14, 1
  s_cmp_gt_u32 s14, 200000
  s_cbranch_scc1 L_spinx_68
  s_cmp_ge_u32 s12, 8
  s_cbranch_scc1 L_spinx_68
  s_sleep 2
  s_branch L_spin_67
L_spinx_68:
  s_cmp_lg_u32 s3, 0
  s_cbranch_scc1 L_rolew_69
  s_lshl_b32 s12, s4, 5
  v_mov_b32 v17, s12
  v_mov_b32 v18, 1
  s_mov_b64 exec, 1
  buffer_atomic_add v18, v17, s[64:67], 0 offen sc0
  s_waitcnt vmcnt(0)
  v_add_u32 v18, 1, v18
  v_mov_b32 v17, 131336
  ds_write_b32 v17, v18
  v_readfirstlane_b32 s12, v18
  s_mov_b64 exec, -1
  s_branch L_rolej_70
L_rolew_69:
  v_mov_b32 v17, 131336
  s_mov_b32 s14, 0
L_spin_71:
  ds_read_b32 v18, v17
  s_waitcnt lgkmcnt(0)
  v_readfirstlane_b32 s12, v18
  s_add_u32 s14, s14, 1
  s_cmp_gt_u32 s14, 200000
  s_cbranch_scc1 L_spinx_72
  s_cmp_ge_u32 s12, 1
  s_cbranch_scc1 L_spinx_72
  s_sleep 2
  s_branch L_spin_71
L_spinx_72:
L_rolej_70:
  s_sub_u32 s21, s12, 1
  s_cmp_lt_u32 s4, 7
  s_cselect_b32 s13, 6, 1
  s_mov_b32 s20, s21
  s_cmp_ge_u32 s21, s13
  s_cbranch_scc1 L_notC_73
  s_mul_i32 s10, s4, 6
  s_add_u32 s10, s10, s21
  s_branch L_isC_65
L_notC_73:
  s_sub_u32 s21, s21, s13
  s_cmp_lt_u32 s21, 16
  s_cbranch_scc1 L_isB_66
  s_sub_u32 s20, s21, 16
  s_add_u32 s20, s20, s13
  v_mov_b32 v17, 131332
  s_mov_b32 s14, 0
L_spin_74:
  ds_read_b32 v18, v17
  s_waitcnt lgkmcnt(0)
  v_readfirstlane_b32 s12, v18
  s_add_u32 s14, s14, 1
  s_cmp_gt_u32 s14, 200000
  s_cbranch_scc1 L_spinx_75
  s_cmp_ge_u32 s12, 8
  s_cbranch_scc1 L_spinx_75
  s_sleep 2
  s_branch L_spin_74
L_spinx_75:
  s_setprio 0
  s_cmp_ge_u32 s20, 16
  s_cbranch_scc1 L_nocoop_76
  s_lshl_b32 s16, s20, 3
  s_add_u32 s16, s16, s3
  v_lshrrev_b32 v112, 5, v0
  v_mul_u32_u24 v112, 2752, v112
  v_and_b32 v113, 31, v0
  v_lshl_add_u32 v112, v113, 4, v112
  s_mul_i32 s12, s4, 384
  v_add_u32 v112, s12, v112
  s_mov_b32 s44, s28
  s_mov_b32 s45, s29
  s_mov_b32 s46, 1409024
  s_mov_b32 s47, 0x20000
  s_mov_b32 s68, s30
  s_mov_b32 s69, s31
  s_mov_b32 s70, 1409024
  s_mov_b32 s71, 0x20000
  s_mov_b32 exec_lo, 0x00ffffff
  s_mov_b32 exec_hi, 0x00ffffff
  s_mul_i32 s17, s16, 5504
  buffer_load_dwordx4 v[32:35], v112, s[44:47], s17 offen
  buffer_load_dwordx4 v[36:39], v112, s[68:71], s17 offen
  s_add_u32 s17, s17, 704512
  buffer_load_dwordx4 v[40:43], v112, s[44:47], s17 offen
  buffer_load_dwordx4 v[44:47], v112, s[68:71], s17 offen
  s_add_u32 s17, s17, 704512
  s_mov_b64 exec, -1
  s_mov_b32 s44, s26
  s_mov_b32 s45, s27
  s_mov_b32 s46, 1024
  s_mov_b32 s47, 0x20000
L_nocoop_76:
  s_waitcnt vmcnt(0)
  s_cmp_lg_u32 s3, 7
  s_cbranch_scc1 L_Rend_64
  s_sub_u32 s21, s21, 16
  s_cmp_ge_u32 s21, 4
  s_cbranch_scc1 L_Rend_64
  s_lshl_b32 s10, s4, 2
  s_add_u32 s10, s10, s21
  v_and_b32 v8, 3, v0
  v_lshlrev_b32 v8, 2, v8
  v_bfe_u32 v14, v0, 5, 1
  v_add_u32 v8, v8, v14
  v_bfe_u32 v14, v0, 4, 1
  v_lshl_add_u32 v8, v14, 1, v8
  s_lshl_b32 s12, s10, 4
  v_add_u32 v8, s12, v8
  v_lshlrev_b32 v14, 3, v8
  v_add_u32 v14, 851968, v14
  v_lshlrev_b32 v8, 1, v8
  v_lshrrev_b32 v6, 2, v0
  v_lshlrev_b32 v6, 11, v6
  v_and_b32 v7, 3, v0
  v_lshl_add_u32 v6, v7, 4, v6
  s_lshl_b32 s12, s10, 6
  s_add_u32 s23, s12, 589824
  s_mul_i32 s12, s10, 3072
  s_add_u32 s24, s12, 655360
  s_setprio 0
  s_mov_b32 s14, 0
L_pollFM_77:
  buffer_load_ushort v24, v8, s[44:47], 0 offen
  buffer_load_dwordx2 v[80:81], v14, s[56:59], 0 offen sc1
  s_mov_b32 s13, 12288
  buffer_load_dwordx2 v[82:83], v14, s[56:59], s13 offen sc1
  s_add_u32 s14, s14, 1
  s_cmp_gt_u32 s14, 200000
  s_cbranch_scc1 L_pollFMx_78
  s_waitcnt vmcnt(0)
  v_xor_b32 v20, s15, v81
  v_xor_b32 v21, s15, v83
  v_or_b32 v20, v20, v21
  v_cmp_ne_u32 vcc, 0, v20
  s_cbranch_vccz L_pollFMx_78
  s_sleep 8
  s_branch L_pollFM_77
L_pollFMx_78:
  s_waitcnt vmcnt(0)
  v_lshlrev_b32 v24, 16, v24
  v_add_u32 v17, 4096, v4
  s_mov_b32 s14, 0
L_pollF_80:
  buffer_load_dwordx4 v[112:115], v17, s[56:59], 0 offen sc1
  s_add_u32 s14, s14, 1
  s_cmp_gt_u32 s14, 200000
  s_cbranch_scc1 L_pollFx_81
  s_waitcnt vmcnt(0)
  v_xor_b32 v20, s15, v112
  v_xor_b32 v21, s15, v113
  v_or_b32 v20, v20, v21
  v_xor_b32 v21, s15, v114
  v_or_b32 v20, v20, v21
  v_xor_b32 v21, s15, v115
  v_or_b32 v20, v20, v21
  v_and_b32 v20, -8, v20
  v_cmp_ne_u32 vcc, 0, v20
  s_cbranch_vccz L_pollFx_81
  s_sleep 8
  s_branch L_pollF_80
L_pollFx_81:
  s_waitcnt vmcnt(0)
  v_mov_b32 v108, 0
  v_mov_b32 v109, 0
  v_mov_b32 v110, 0
  v_mov_b32 v111, 0
  s_cmp_lg_u32 s3, 7
  s_cbranch_scc1 L_wn_84
  s_mov_b64 exec, 0
  s_branch SEG_F_0
WRET_F_0:
  s_mov_b64 exec, -1
  s_branch L_warmdone_83
L_wn_84:
L_warmdone_83:
SEG_F_0:
PAD_F_0:
  s_cbranch_execz PAD_F_1
  s_mov_b32 s14, 0
L_pollFA_85:
  buffer_load_dwordx4 v[84:87], v6, s[56:59], s23 offen sc1
  s_add_u32 s14, s14, 1
  s_cmp_gt_u32 s14, 200000
  s_cbranch_scc1 L_pollFAx_86
  s_waitcnt vmcnt(0)
  v_max3_u32 v18, v84, v85, v86
  v_max_u32 v18, v18, v87
  v_cmp_eq_u32 vcc, -1, v18
  s_cbranch_vccz L_pollFAx_86
  s_sleep 1
  s_branch L_pollFA_85
L_pollFAx_86:
PAD_F_1:
  s_cbranch_execz PAD_F_2
  s_waitcnt vmcnt(0)
  s_setprio 3
  v_permlane32_swap_b32 v84, v85
  v_permlane32_swap_b32 v86, v87
  v_add_f32 v84, v84, v85
  v_add_f32 v86, v86, v87
  s_nop 1
  v_permlane16_swap_b32 v84, v86
  v_add_f32 v84, v84, v86
  s_nop 1
  v_add_f32_dpp v84, v84, v84 row_ror:8 row_mask:0xf bank_mask:0xf
  v_mov_b32 v18, v84
  s_nop 1
PAD_F_2:
  s_cbranch_execz PAD_F_3
  v_add_f32_dpp v84, v18, v18 row_shl:4 row_mask:0xf bank_mask:0x5
  s_nop 1
  v_add_f32_dpp v84, v18, v18 row_shr:4 row_mask:0xf bank_mask:0xa
  v_cvt_pk_bf16_f32 v84, v84, v84
  v_and_b32 v84, 0xffff0000, v84
  v_mul_f32 v84, v80, v84
  v_cvt_pk_bf16_f32 v84, v84, v84
  v_and_b32 v84, 0xffff0000, v84
  v_add_f32 v26, v24, v84
PAD_F_3:
  s_cbranch_execz PAD_F_4
  v_cvt_pk_bf16_f32 v26, v26, v26
  v_and_b32 v26, 0xffff0000, v26
  s_mov_b32 s14, 0
  s_mov_b32 s9, 7
L_pollFC_88:
  s_bitcmp1_b32 s9, 0
  s_cbranch_scc0 L_pollFCs_90
  buffer_load_dwordx4 v[100:103], v4, s[56:59], s24 offen offset:0 sc1
L_pollFCs_90:
  s_bitcmp1_b32 s9, 1
  s_cbranch_scc0 L_pollFCs_91
  buffer_load_dwordx4 v[104:107], v4, s[56:59], s24 offen offset:1024 sc1
L_pollFCs_91:
  s_bitcmp1_b32 s9, 2
PAD_F_4:
  s_cbranch_execz PAD_F_5
  s_cbranch_scc0 L_pollFCs_92
  s_mov_b32 exec_hi, 0xfff
  buffer_load_dwordx4 v[108:111], v4, s[56:59], s24 offen offset:2048 sc1
  s_mov_b64 exec, -1
L_pollFCs_92:
  s_add_u32 s14, s14, 1
  s_cmp_gt_u32 s14, 200000
  s_cbranch_scc1 L_pollFCx_89
  s_waitcnt vmcnt(0)
  s_bitcmp1_b32 s9, 0
  s_cbranch_scc0 L_pollFCc_93
  v_max3_u32 v18, v100, v101, v102
PAD_F_5:
  s_cbranch_execz PAD_F_6
  v_max_u32 v18, v18, v103
  v_cmp_eq_u32 vcc, -1, v18
  s_cbranch_vccnz L_pollFCc_93
  s_bitset0_b32 s9, 0
L_pollFCc_93:
  s_bitcmp1_b32 s9, 1
  s_cbranch_scc0 L_pollFCc_94
  v_max3_u32 v18, v104, v105, v106
  v_max_u32 v18, v18, v107
  v_cmp_eq_u32 vcc, -1, v18
  s_cbranch_vccnz L_pollFCc_94
  s_bitset0_b32 s9, 1
L_pollFCc_94:
  s_bitcmp1_b32 s9, 2
  s_cbranch_scc0 L_pollFCc_95
PAD_F_6:
  s_cbranch_execz PAD_F_7
  v_max3_u32 v18, v108, v109, v110
  v_max_u32 v18, v18, v111
  v_cmp_eq_u32 vcc, -1, v18
  s_cbranch_vccnz L_pollFCc_95
  s_bitset0_b32 s9, 2
L_pollFCc_95:
  s_cmp_eq_u32 s9, 0
  s_cbranch_scc1 L_pollFCx_89
  s_branch L_pollFC_88
L_pollFCx_89:
  s_waitcnt vmcnt(0)
  v_add_f32 v100, v100, v104
  v_add_f32 v101, v101, v105
  v_add_f32 v102, v102, v106
  v_add_f32 v103, v103, v107
  v_add_f32 v100, v100, v108
PAD_F_7:
  s_cbranch_execz PAD_F_8
  v_add_f32 v101, v101, v109
  v_add_f32 v102, v102, v110
  v_add_f32 v103, v103, v111
  v_permlane32_swap_b32 v100, v101
  s_nop 0
  v_permlane32_swap_b32 v102, v103
  v_add_f32 v100, v100, v101
  v_add_f32 v102, v102, v103
  s_nop 1
  v_permlane16_swap_b32 v100, v102
  v_add_f32 v100, v100, v102
  s_nop 1
  v_add_f32_dpp v100, v100, v100 row_ror:8 row_mask:0xf bank_mask:0xf
  v_mov_b32 v18, v100
PAD_F_8:
  s_cbranch_execz PAD_F_9
  s_nop 1
  v_add_f32_dpp v100, v18, v18 row_shl:4 row_mask:0xf bank_mask:0x5
  s_nop 1
  v_add_f32_dpp v100, v18, v18 row_shr:4 row_mask:0xf bank_mask:0xa
  v_cvt_pk_bf16_f32 v100, v100, v100
  v_and_b32 v100, 0xffff0000, v100
  v_mul_f32 v100, v82, v100
  v_cvt_pk_bf16_f32 v100, v100, v100
  v_and_b32 v100, 0xffff0000, v100
PAD_F_9:
  s_cbranch_execz PAD_F_10
  v_add_f32 v100, v26, v100
  v_cvt_pk_bf16_f32 v100, v100, v100
  s_mov_b32 exec_lo, 0x000f000f
  s_mov_b32 exec_hi, 0x000f000f
  buffer_store_short v100, v8, s[76:79], 0 offen
  s_mov_b64 exec, -1
PAD_F_10:
  s_cbranch_execz WRET_F_0
  s_cmp_lg_u32 s10, 0
  s_cbranch_scc1 L_Rend_64
  s_mov_b64 exec, 1
  v_mov_b32 v18, s15
  v_mov_b32 v19, 0
  buffer_store_dword v18, v19, s[56:59], 0 offen sc1
  s_mov_b64 exec, -1
  s_branch L_Rend_64
  s_branch L_Rend_64
L_isB_66:
  v_bfe_u32 v3, v2, 1, 2
  v_and_b32 v13, 1, v2
  v_cmp_eq_u32 vcc, 1, v13
  v_mov_b32 v13, 0xffff
  v_mov_b32 v14, 0xffff0000
  v_cndmask_b32 v13, v13, v14, vcc
  v_cmp_eq_u32 vcc, 0, v3
  s_nop 1
  v_cndmask_b32 v9, 0, v13, vcc
  v_cmp_eq_u32 vcc, 1, v3
  s_nop 1
  v_cndmask_b32 v10, 0, v13, vcc
  v_cmp_eq_u32 vcc, 2, v3
  s_nop 1
  v_cndmask_b32 v11, 0, v13, vcc
  v_cmp_eq_u32 vcc, 3, v3
  s_nop 1
  v_cndmask_b32 v12, 0, v13, vcc
  v_lshrrev_b32 v5, 3, v0
  v_lshlrev_b32 v5, 12, v5
  v_and_b32 v6, 7, v0
  v_lshl_add_u32 v5, v6, 4, v5
  s_lshr_b32 s16, s21, 3
  s_and_b32 s17, s21, 7
  s_lshl_b32 s12, s4, 19
  s_lshl_b32 s13, s16, 18
  s_add_u32 s12, s12, s13
  s_lshl_b32 s13, s3, 15
  s_add_u32 s12, s12, s13
  s_lshl_b32 s13, s17, 7
  s_add_u32 s22, s12, s13
  s_lshl_b32 s12, s4, 2
  s_lshl_b32 s13, s16, 1
  s_add_u32 s12, s12, s13
  s_lshr_b32 s13, s3, 2
  s_add_u32 s12, s12, s13
  s_mul_i32 s12, s12, 4224
  s_add_u32 s23, s12, 393216
  v_lshrrev_b32 v7, 3, v0
  v_lshlrev_b32 v7, 2, v7
  v_and_b32 v8, 3, v0
  v_add_u32 v7, v7, v8
  s_and_b32 s13, s3, 3
  s_lshl_b32 s13, s13, 5
  v_add_u32 v7, s13, v7
  v_lshlrev_b32 v7, 2, v7
  v_mul_u32_u24 v8, 528, v6
  v_add_u32 v8, 512, v8
  v_and_b32 v30, 7, v0
  v_lshlrev_b32 v30, 8, v30
  v_bfe_u32 v31, v0, 4, 1
  v_lshl_add_u32 v30, v31, 7, v30
  s_lshl_b32 s12, s3, 2
  s_add_u32 s12, s12, 135616
  v_add_u32 v30, s12, v30
  v_lshlrev_b32 v28, 2, v0
  v_lshlrev_b32 v29, 5, v0
  v_add_u32 v29, 135616, v29
  s_lshl_b32 s12, s4, 12
  s_lshl_b32 s13, s21, 8
  s_add_u32 s12, s12, s13
  s_add_u32 s24, s12, 589824
  v_add_u32 v17, 4096, v4
  s_mov_b32 s14, 0
L_pollF_96:
  buffer_load_dwordx4 v[112:115], v17, s[56:59], 0 offen sc1
  s_add_u32 s14, s14, 1
  s_cmp_gt_u32 s14, 200000
  s_cbranch_scc1 L_pollFx_97
  s_waitcnt vmcnt(0)
  v_xor_b32 v20, s15, v112
  v_xor_b32 v21, s15, v113
  v_or_b32 v20, v20, v21
  v_xor_b32 v21, s15, v114
  v_or_b32 v20, v20, v21
  v_xor_b32 v21, s15, v115
  v_or_b32 v20, v20, v21
  v_and_b32 v20, -8, v20
  v_cmp_ne_u32 vcc, 0, v20
  s_cbranch_vccz L_pollFx_97
  s_sleep 8
  s_branch L_pollF_96
L_pollFx_97:
  s_waitcnt vmcnt(0)
  v_mov_b32 v17, 131332
  s_mov_b32 s14, 0
L_spin_99:
  ds_read_b32 v18, v17
  s_waitcnt lgkmcnt(0)
  v_readfirstlane_b32 s12, v18
  s_add_u32 s14, s14, 1
  s_cmp_gt_u32 s14, 200000
  s_cbranch_scc1 L_spinx_100
  s_cmp_ge_u32 s12, 8
  s_cbranch_scc1 L_spinx_100
  s_sleep 2
  s_branch L_spin_99
L_spinx_100:
  s_setprio 0
  buffer_load_dwordx4 v[32:35], v5, s[36:39], s22 offen offset:0 nt
  buffer_load_dwordx4 v[36:39], v5, s[36:39], s22 offen offset:1024 nt
  buffer_load_dwordx4 v[40:43], v5, s[36:39], s22 offen offset:2048 nt
  buffer_load_dwordx4 v[44:47], v5, s[36:39], s22 offen offset:3072 nt
  s_setprio 0
  v_mov_b32 v17, 131360
  s_mov_b32 s14, 0
L_spin_101:
  ds_read_b32 v18, v17
  s_waitcnt lgkmcnt(0)
  v_readfirstlane_b32 s12, v18
  s_add_u32 s14, s14, 1
  s_cmp_gt_u32 s14, 200000
  s_cbranch_scc1 L_spinx_102
  s_cmp_ge_u32 s12, 1
  s_cbranch_scc1 L_spinx_102
  s_sleep 2
  s_branch L_spin_101
L_spinx_102:
  s_mov_b32 s14, 0
  s_mov_b32 s9, 7
L_pollA_103:
  s_bitcmp1_b32 s9, 0
  s_cbranch_scc0 L_pollAs_105
  buffer_load_dword v64, v7, s[56:59], s23 offen offset:0 sc1
  buffer_load_dword v65, v7, s[56:59], s23 offen offset:528 sc1
  buffer_load_dword v66, v7, s[56:59], s23 offen offset:1056 sc1
L_pollAs_105:
  s_bitcmp1_b32 s9, 1
  s_cbranch_scc0 L_pollAs_106
  buffer_load_dword v67, v7, s[56:59], s23 offen offset:1584 sc1
  buffer_load_dword v68, v7, s[56:59], s23 offen offset:2112 sc1
  buffer_load_dword v69, v7, s[56:59], s23 offen offset:2640 sc1
L_pollAs_106:
  s_bitcmp1_b32 s9, 2
  s_cbranch_scc0 L_pollAs_107
  buffer_load_dword v70, v7, s[56:59], s23 offen offset:3168 sc1
  buffer_load_dword v71, v7, s[56:59], s23 offen offset:3696 sc1
  buffer_load_dwordx2 v[72:73], v8, s[56:59], s23 offen sc1
L_pollAs_107:
  s_add_u32 s14, s14, 1
  s_cmp_gt_u32 s14, 200000
  s_cbranch_scc1 L_pollAx_104
  s_waitcnt vmcnt(0)
  s_bitcmp1_b32 s9, 0
  s_cbranch_scc0 L_pollAc_108
  v_max3_u32 v20, v64, v65, v66
  v_cmp_eq_u32 vcc, -1, v20
  s_cbranch_vccnz L_pollAc_108
  s_bitset0_b32 s9, 0
L_pollAc_108:
  s_bitcmp1_b32 s9, 1
  s_cbranch_scc0 L_pollAc_109
  v_max3_u32 v20, v67, v68, v69
  v_cmp_eq_u32 vcc, -1, v20
  s_cbranch_vccnz L_pollAc_109
  s_bitset0_b32 s9, 1
L_pollAc_109:
  s_bitcmp1_b32 s9, 2
  s_cbranch_scc0 L_pollAc_110
  v_max3_u32 v20, v70, v71, v72
  v_max_u32 v20, v20, v73
  v_cmp_eq_u32 vcc, -1, v20
  s_cbranch_vccnz L_pollAc_110
  s_bitset0_b32 s9, 2
L_pollAc_110:
  s_cmp_eq_u32 s9, 0
  s_cbranch_scc1 L_pollAx_104
  s_branch L_pollA_103
L_pollAx_104:
  s_waitcnt vmcnt(0)
  s_setprio 3
  v_mov_b32 v20, v72
  s_nop 1
  v_max_f32_dpp v20, v20, v20 quad_perm:[1,0,3,2] row_mask:0xf bank_mask:0xf
  s_nop 1
  v_max_f32_dpp v20, v20, v20 quad_perm:[2,3,0,1] row_mask:0xf bank_mask:0xf
  s_nop 1
  v_max_f32_dpp v20, v20, v20 row_half_mirror row_mask:0xf bank_mask:0xf
  v_sub_f32 v72, v72, v20
  v_mul_f32 v72, 0x3fb8aa3b, v72
  v_exp_f32 v72, v72
  s_nop 0
  v_mul_f32 v73, v72, v73
  v_mul_f32_dpp v20, v72, v64 row_newbcast:0 row_mask:0xf bank_mask:0xf
  v_mul_f32_dpp v21, v72, v65 row_newbcast:1 row_mask:0xf bank_mask:0xf
  v_add_f32_dpp v73, v73, v73 quad_perm:[1,0,3,2] row_mask:0xf bank_mask:0xf
  v_fmac_f32_dpp v20, v72, v66 row_newbcast:2 row_mask:0xf bank_mask:0xf
  v_fmac_f32_dpp v21, v72, v67 row_newbcast:3 row_mask:0xf bank_mask:0xf
  v_add_f32_dpp v73, v73, v73 quad_perm:[2,3,0,1] row_mask:0xf bank_mask:0xf
  v_fmac_f32_dpp v20, v72, v68 row_newbcast:4 row_mask:0xf bank_mask:0xf
  v_fmac_f32_dpp v21, v72, v69 row_newbcast:5 row_mask:0xf bank_mask:0xf
  v_add_f32_dpp v73, v73, v73 row_half_mirror row_mask:0xf bank_mask:0xf
  v_fmac_f32_dpp v20, v72, v70 row_newbcast:6 row_mask:0xf bank_mask:0xf
  v_fmac_f32_dpp v21, v72, v71 row_newbcast:7 row_mask:0xf bank_mask:0xf
  v_rcp_f32 v73, v73
  v_add_f32 v20, v20, v21
  v_mul_f32 v20, v20, v73
  v_cvt_pk_bf16_f32 v18, v20, v20
  s_nop 1
  v_and_b32_dpp v24, v18, v9 quad_perm:[0,0,0,0] row_mask:0xf bank_mask:0xf
  v_and_b32_dpp v25, v18, v10 quad_perm:[0,0,0,0] row_mask:0xf bank_mask:0xf
  v_and_b32_dpp v26, v18, v11 quad_perm:[0,0,0,0] row_mask:0xf bank_mask:0xf
  v_and_b32_dpp v27, v18, v12 quad_perm:[0,0,0,0] row_mask:0xf bank_mask:0xf
  v_and_b32_dpp v76, v18, v9 quad_perm:[1,1,1,1] row_mask:0xf bank_mask:0xf
  v_and_b32_dpp v77, v18, v10 quad_perm:[1,1,1,1] row_mask:0xf bank_mask:0xf
  v_and_b32_dpp v78, v18, v11 quad_perm:[1,1,1,1] row_mask:0xf bank_mask:0xf
  v_and_b32_dpp v79, v18, v12 quad_perm:[1,1,1,1] row_mask:0xf bank_mask:0xf
  v_mfma_f32_16x16x32_bf16 v[20:23], v[24:27], v[32:35], 0
  v_and_b32_dpp v80, v18, v9 quad_perm:[2,2,2,2] row_mask:0xf bank_mask:0xf
  v_and_b32_dpp v81, v18, v10 quad_perm:[2,2,2,2] row_mask:0xf bank_mask:0xf
  v_and_b32_dpp v82, v18, v11 quad_perm:[2,2,2,2] row_mask:0xf bank_mask:0xf
  v_and_b32_dpp v83, v18, v12 quad_perm:[2,2,2,2] row_mask:0xf bank_mask:0xf
  v_mfma_f32_16x16x32_bf16 v[20:23], v[76:79], v[36:39], v[20:23]
  v_and_b32_dpp v24, v18, v9 quad_perm:[3,3,3,3] row_mask:0xf bank_mask:0xf
  v_and_b32_dpp v25, v18, v10 quad_perm:[3,3,3,3] row_mask:0xf bank_mask:0xf
  v_and_b32_dpp v26, v18, v11 quad_perm:[3,3,3,3] row_mask:0xf bank_mask:0xf
  v_and_b32_dpp v27, v18, v12 quad_perm:[3,3,3,3] row_mask:0xf bank_mask:0xf
  v_mfma_f32_16x16x32_bf16 v[20:23], v[80:83], v[40:43], v[20:23]
  s_nop 0
  v_mfma_f32_16x16x32_bf16 v[20:23], v[24:27], v[44:47], v[20:23]
  s_nop 7
  v_mov_b32 v84, v20
  v_mov_b32 v85, v21
  v_mov_b32 v86, v22
  v_mov_b32 v87, v23
  v_permlane32_swap_b32 v20, v84
  v_permlane32_swap_b32 v21, v85
  v_permlane32_swap_b32 v22, v86
  v_permlane32_swap_b32 v23, v87
  v_add_f32_dpp v20, v84, v20 row_ror:8 row_mask:0xf bank_mask:0xf
  v_add_f32_dpp v21, v85, v21 row_ror:8 row_mask:0xf bank_mask:0xf
  v_add_f32_dpp v22, v86, v22 row_ror:8 row_mask:0xf bank_mask:0xf
  v_add_f32_dpp v23, v87, v23 row_ror:8 row_mask:0xf bank_mask:0xf
  s_mov_b32 exec_lo, 0x00ff00ff
  s_mov_b32 exec_hi, 0
  ds_write_b32 v30, v20 offset:0
  ds_write_b32 v30, v21 offset:32
  ds_write_b32 v30, v22 offset:64
  ds_write_b32 v30, v23 offset:96
  s_mov_b64 exec, -1
  s_waitcnt lgkmcnt(0)
  s_barrier
  s_cmp_lg_u32 s3, 0
  s_cbranch_scc1 L_Rend_64
  ds_read_b128 v[44:47], v29
  ds_read_b128 v[48:51], v29 offset:16
  s_waitcnt lgkmcnt(0)
  v_add_f32 v44, v44, v45
  v_add_f32 v46, v46, v47
  v_add_f32 v48, v48, v49
  v_add_f32 v50, v50, v51
  v_add_f32 v44, v44, v46
  v_add_f32 v48, v48, v50
  v_add_f32 v44, v44, v48
  v_min_u32 v20, -2, v44
  s_nop 1
  v_mov_b32_dpp v21, v20 quad_perm:[1,1,1,1] row_mask:0xf bank_mask:0xf
  v_mov_b32_dpp v22, v20 quad_perm:[2,2,2,2] row_mask:0xf bank_mask:0xf
  v_mov_b32_dpp v23, v20 quad_perm:[3,3,3,3] row_mask:0xf bank_mask:0xf
  s_mov_b32 exec_lo, 0x11111111
  s_mov_b32 exec_hi, 0x11111111
  buffer_store_dwordx4 v[20:23], v28, s[56:59], s24 offen sc1
  s_mov_b64 exec, -1
  s_branch L_Rend_64
L_isC_65:
  v_bfe_u32 v3, v2, 1, 2
  v_and_b32 v13, 1, v2
  v_cmp_eq_u32 vcc, 1, v13
  v_mov_b32 v13, 0xffff
  v_mov_b32 v14, 0xffff0000
  v_cndmask_b32 v13, v13, v14, vcc
  v_cmp_eq_u32 vcc, 0, v3
  s_nop 1
  v_cndmask_b32 v9, 0, v13, vcc
  v_cmp_eq_u32 vcc, 1, v3
  s_nop 1
  v_cndmask_b32 v10, 0, v13, vcc
  v_cmp_eq_u32 vcc, 2, v3
  s_nop 1
  v_cndmask_b32 v11, 0, v13, vcc
  v_cmp_eq_u32 vcc, 3, v3
  s_nop 1
  v_cndmask_b32 v12, 0, v13, vcc
  s_lshl_b32 s11, s3, 6
  v_lshlrev_b32 v5, 2, v2
  v_bfe_u32 v6, v0, 5, 1
  v_add_u32 v5, v5, v6
  v_bfe_u32 v6, v0, 4, 1
  v_lshl_add_u32 v5, v6, 1, v5
  v_add_u32 v5, s11, v5
  v_lshlrev_b32 v6, 1, v5
  v_lshlrev_b32 v7, 3, v5
  v_add_u32 v7, 851968, v7
  v_and_b32 v8, 3, v0
  v_lshlrev_b32 v8, 2, v8
  v_bfe_u32 v14, v0, 5, 1
  v_add_u32 v8, v8, v14
  v_bfe_u32 v14, v0, 4, 1
  v_lshl_add_u32 v8, v14, 1, v8
  s_lshl_b32 s12, s10, 4
  v_add_u32 v8, s12, v8
  v_min_u32 v8, 511, v8
  v_lshlrev_b32 v14, 3, v8
  v_add_u32 v14, 864256, v14
  v_bfe_u32 v15, v0, 3, 1
  v_lshlrev_b32 v15, 5, v15
  v_bfe_u32 v16, v0, 5, 1
  v_add_u32 v15, v15, v16
  v_bfe_u32 v16, v0, 4, 1
  v_lshl_add_u32 v15, v16, 1, v15
  v_add_u32 v15, s11, v15
  v_mul_u32_u24 v15, 2752, v15
  v_and_b32 v16, 3, v0
  v_lshl_add_u32 v15, v16, 4, v15
  s_lshl_b32 s12, s10, 6
  v_add_u32 v15, s12, v15
  v_and_b32 v16, 4, v0
  v_cmp_eq_u32 vcc, 0, v16
  v_mov_b32 v16, s30
  v_mov_b32 v17, s28
  v_cndmask_b32 v22, v16, v17, vcc
  v_mov_b32 v16, s31
  v_mov_b32 v17, s29
  v_cndmask_b32 v23, v16, v17, vcc
  v_add_co_u32 v22, vcc, v22, v15
  s_nop 1
  v_addc_co_u32 v23, vcc, 0, v23, vcc
  v_lshrrev_b32 v16, 3, v0
  v_lshlrev_b32 v16, 12, v16
  v_and_b32 v17, 7, v0
  v_lshl_add_u32 v16, v17, 4, v16
  s_lshl_b32 s12, s10, 15
  s_lshl_b32 s13, s3, 7
  s_add_u32 s22, s12, s13
  s_mov_b32 s60, 11008
  s_mov_b32 s61, 0
  s_cmp_lg_u32 s3, 0
  s_cbranch_scc1 L_wn_112
  s_mov_b64 exec, 0
  s_branch SEG_C_0
WRET_C_0:
  s_mov_b64 exec, -1
  s_branch L_warmdone_111
L_wn_112:
  s_cmp_lg_u32 s3, 1
  s_cbranch_scc1 L_wn_113
  s_mov_b64 exec, 0
  s_branch SEG_C_1
WRET_C_1:
  s_mov_b64 exec, -1
  s_branch L_warmdone_111
L_wn_113:
  s_cmp_lg_u32 s3, 2
  s_cbranch_scc1 L_wn_114
  s_mov_b64 exec, 0
  s_branch SEG_C_2
WRET_C_2:
  s_mov_b64 exec, -1
  s_branch L_warmdone_111
L_wn_114:
  s_cmp_lg_u32 s3, 3
  s_cbranch_scc1 L_wn_115
  s_mov_b64 exec, 0
  s_branch SEG_C_3
WRET_C_3:
  s_mov_b64 exec, -1
  s_branch L_warmdone_111
L_wn_115:
  s_cmp_lg_u32 s3, 4
  s_cbranch_scc1 L_wn_116
  s_mov_b64 exec, 0
  s_branch SEG_C_4
WRET_C_4:
  s_mov_b64 exec, -1
  s_branch L_warmdone_111
L_wn_116:
  s_cmp_lg_u32 s3, 5
  s_cbranch_scc1 L_wn_117
  s_mov_b64 exec, 0
  s_branch SEG_C_5
WRET_C_5:
  s_mov_b64 exec, -1
  s_branch L_warmdone_111
L_wn_117:
  s_cmp_lg_u32 s3, 6
  s_cbranch_scc1 L_wn_118
  s_mov_b64 exec, 0
  s_branch SEG_C_6
WRET_C_6:
  s_mov_b64 exec, -1
  s_branch L_warmdone_111
L_wn_118:
  s_cmp_lg_u32 s3, 7
  s_cbranch_scc1 L_wn_119
  s_mov_b64 exec, 0
  s_branch SEG_C_7
WRET_C_7:
  s_mov_b64 exec, -1
  s_branch L_warmdone_111
L_wn_119:
L_warmdone_111:
  s_mov_b32 s14, 0
L_pollM_120:
  buffer_load_ushort v24, v6, s[44:47], 0 offen
  buffer_load_dwordx2 v[80:81], v7, s[56:59], 0 offen sc1
  s_mov_b32 s13, 4096
  buffer_load_dwordx2 v[82:83], v7, s[56:59], s13 offen sc1
  s_mov_b32 s13, 8192
  buffer_load_dwordx2 v[84:85], v7, s[56:59], s13 offen sc1
  buffer_load_dwordx2 v[86:87], v14, s[56:59], 0 offen sc1
  s_add_u32 s14, s14, 1
  s_cmp_gt_u32 s14, 200000
  s_cbranch_scc1 L_pollMx_121
  s_waitcnt vmcnt(0)
  v_xor_b32 v20, s15, v81
  v_xor_b32 v21, s15, v83
  v_or_b32 v20, v20, v21
  v_xor_b32 v21, s15, v85
  v_or_b32 v20, v20, v21
  v_xor_b32 v21, s15, v87
  v_or_b32 v20, v20, v21
  v_cmp_ne_u32 vcc, 0, v20
  s_cbranch_vccz L_pollMx_121
  s_sleep 8
  s_branch L_pollM_120
L_pollMx_121:
  s_waitcnt vmcnt(0)
  v_mov_b32 v26, v80
  v_mov_b32 v28, v82
  v_mov_b32 v30, v84
  v_mov_b32 v25, v86
  v_add_f32 v30, 1.0, v30
  v_cvt_pk_bf16_f32 v30, v30, v30
  v_and_b32 v30, 0xffff0000, v30
  v_lshlrev_b32 v24, 16, v24
  v_add_u32 v17, 4096, v4
  s_mov_b32 s14, 0
L_pollF_123:
  buffer_load_dwordx4 v[112:115], v17, s[56:59], 0 offen sc1
  s_add_u32 s14, s14, 1
  s_cmp_gt_u32 s14, 200000
  s_cbranch_scc1 L_pollFx_124
  s_waitcnt vmcnt(0)
  v_xor_b32 v20, s15, v112
  v_xor_b32 v21, s15, v113
  v_or_b32 v20, v20, v21
  v_xor_b32 v21, s15, v114
  v_or_b32 v20, v20, v21
  v_xor_b32 v21, s15, v115
  v_or_b32 v20, v20, v21
  v_and_b32 v20, -8, v20
  v_cmp_ne_u32 vcc, 0, v20
  s_cbranch_vccz L_pollFx_124
  s_sleep 8
  s_branch L_pollF_123
L_pollFx_124:
  s_waitcnt vmcnt(0)
  v_mov_b32 v17, 131332
  s_mov_b32 s14, 0
L_spin_126:
  ds_read_b32 v18, v17
  s_waitcnt lgkmcnt(0)
  v_readfirstlane_b32 s12, v18
  s_add_u32 s14, s14, 1
  s_cmp_gt_u32 s14, 200000
  s_cbranch_scc1 L_spinx_127
  s_cmp_ge_u32 s12, 8
  s_cbranch_scc1 L_spinx_127
  s_sleep 2
  s_branch L_spin_126
L_spinx_127:
  s_setprio 0
  buffer_load_dwordx4 v[64:67], v16, s[72:75], s22 offen offset:0 nt
  buffer_load_dwordx4 v[68:71], v16, s[72:75], s22 offen offset:1024 nt
  buffer_load_dwordx4 v[72:75], v16, s[72:75], s22 offen offset:2048 nt
  buffer_load_dwordx4 v[76:79], v16, s[72:75], s22 offen offset:3072 nt
  s_cmp_ge_u32 s20, 16
  s_cbranch_scc1 L_nocoop_128
  s_lshl_b32 s16, s20, 3
  s_add_u32 s16, s16, s3
  v_lshrrev_b32 v112, 5, v0
  v_mul_u32_u24 v112, 2752, v112
  v_and_b32 v113, 31, v0
  v_lshl_add_u32 v112, v113, 4, v112
  s_mul_i32 s12, s4, 384
  v_add_u32 v112, s12, v112
  s_mov_b32 s44, s28
  s_mov_b32 s45, s29
  s_mov_b32 s46, 1409024
  s_mov_b32 s47, 0x20000
  s_mov_b32 s68, s30
  s_mov_b32 s69, s31
  s_mov_b32 s70, 1409024
  s_mov_b32 s71, 0x20000
  s_mov_b32 exec_lo, 0x00ffffff
  s_mov_b32 exec_hi, 0x00ffffff
  s_mul_i32 s17, s16, 5504
  buffer_load_dwordx4 v[32:35], v112, s[44:47], s17 offen
  buffer_load_dwordx4 v[36:39], v112, s[68:71], s17 offen
  s_add_u32 s17, s17, 704512
  buffer_load_dwordx4 v[40:43], v112, s[44:47], s17 offen
  buffer_load_dwordx4 v[44:47], v112, s[68:71], s17 offen
  s_add_u32 s17, s17, 704512
  s_mov_b64 exec, -1
  s_mov_b32 s44, s26
  s_mov_b32 s45, s27
  s_mov_b32 s46, 1024
  s_mov_b32 s47, 0x20000
L_nocoop_128:
  s_setprio 0
  v_lshlrev_b32 v6, 2, v5
  v_add_u32 v17, 139712, v6
  v_lshlrev_b32 v6, 11, v1
  v_lshl_add_u32 v6, v2, 4, v6
  s_lshl_b32 s12, s3, 8
  s_add_u32 s12, s12, 589824
  v_add_u32 v6, s12, v6
  s_lshl_b32 s12, s3, 3
  s_add_u32 s12, s12, 131456
  v_mov_b32 v15, s12
  v_and_b32 v3, 7, v0
  v_lshlrev_b32 v3, 3, v3
  v_add_u32 v3, 131456, v3
  v_and_b32 v27, 7, v0
  v_lshlrev_b32 v27, 8, v27
  v_bfe_u32 v31, v0, 4, 1
  v_lshl_add_u32 v27, v31, 7, v27
  s_lshl_b32 s12, s3, 2
  s_add_u32 s12, s12, 135616
  v_add_u32 v27, s12, v27
  v_lshrrev_b32 v13, 3, v0
  v_lshlrev_b32 v13, 2, v13
  v_and_b32 v31, 3, v0
  v_add_u32 v13, v13, v31
  v_lshlrev_b32 v13, 5, v13
  v_add_u32 v13, 135616, v13
  v_and_b32 v14, 7, v0
  v_lshlrev_b32 v14, 3, v14
  v_bfe_u32 v31, v0, 4, 1
  v_lshl_add_u32 v14, v31, 2, v14
  v_add_u32 v14, s11, v14
  v_lshrrev_b32 v31, 4, v14
  v_mul_u32_u24 v31, 3072, v31
  v_and_b32 v14, 15, v14
  v_lshl_add_u32 v14, v14, 2, v31
  s_lshl_b32 s12, s10, 6
  s_add_u32 s23, s12, 655360
  s_mul_i32 s12, s10, 3072
  s_add_u32 s24, s12, 655360
  v_lshlrev_b32 v29, 2, v8
  v_add_u32 v29, 139712, v29
  v_lshlrev_b32 v8, 1, v8
  v_mov_b32 v7, 0x3d372713
SEG_C_0:
PAD_C_0:
  s_cbranch_execz PAD_C_1
  v_mov_b32 v18, 131360
  s_mov_b32 s14, 0
L_spin_129:
  ds_read_b32 v19, v18
  s_waitcnt lgkmcnt(0)
  v_readfirstlane_b32 s12, v19
  s_add_u32 s14, s14, 1
  s_cmp_gt_u32 s14, 200000
  s_cbranch_scc1 L_spinx_130
  s_cmp_ge_u32 s12, 1
  s_cbranch_scc1 L_spinx_130
  s_sleep 2
  s_branch L_spin_129
L_spinx_130:
PAD_C_1:
  s_cbranch_execz PAD_C_2
  s_mov_b32 s14, 0
  s_mov_b32 s9, 15
  s_mov_b32 s97, 0
L_pollB_131:
  s_bitcmp1_b32 s9, 0
  s_cbranch_scc0 L_pollBs_133
  s_mov_b32 s13, 0
  buffer_load_dwordx4 v[80:83], v6, s[56:59], s13 offen sc1
L_pollBs_133:
  s_bitcmp1_b32 s9, 1
  s_cbranch_scc0 L_pollBs_134
  s_mov_b32 s13, 8192
  buffer_load_dwordx4 v[84:87], v6, s[56:59], s13 offen sc1
L_pollBs_134:
  s_bitcmp1_b32 s9, 2
PAD_C_2:
  s_cbranch_execz PAD_C_3
  s_cbranch_scc0 L_pollBs_135
  s_mov_b32 s13, 16384
  buffer_load_dwordx4 v[88:91], v6, s[56:59], s13 offen sc1
L_pollBs_135:
  s_bitcmp1_b32 s9, 3
  s_cbranch_scc0 L_pollBs_136
  s_mov_b32 s13, 24576
  buffer_load_dwordx4 v[92:95], v6, s[56:59], s13 offen sc1
L_pollBs_136:
  s_add_u32 s14, s14, 1
  s_cmp_gt_u32 s14, 200000
  s_cbranch_scc1 L_pollBx_132
PAD_C_3:
  s_cbranch_execz PAD_C_4
  s_waitcnt vmcnt(0)
  s_bitcmp1_b32 s9, 0
  s_cbranch_scc0 L_pollBc_137
  v_max3_u32 v18, v80, v81, v82
  v_max_u32 v18, v18, v83
  v_cmp_eq_u32 vcc, -1, v18
  s_cbranch_vccnz L_pollBc_137
  s_bitset0_b32 s9, 0
L_pollBc_137:
  s_bitcmp1_b32 s9, 1
  s_cbranch_scc0 L_pollBc_138
  v_max3_u32 v18, v84, v85, v86
  v_max_u32 v18, v18, v87
  v_cmp_eq_u32 vcc, -1, v18
PAD_C_4:
  s_cbranch_execz WRET_C_0
  s_cbranch_vccnz L_pollBc_138
  s_bitset0_b32 s9, 1
L_pollBc_138:
  s_bitcmp1_b32 s9, 2
  s_cbranch_scc0 L_pollBc_139
  v_max3_u32 v18, v88, v89, v90
  v_max_u32 v18, v18, v91
  v_cmp_eq_u32 vcc, -1, v18
  s_cbranch_vccnz L_pollBc_139
  s_bitset0_b32 s9, 2
L_pollBc_139:
  s_bitcmp1_b32 s9, 3
  s_cbranch_scc0 L_pollBc_140
  v_max3_u32 v18, v92, v93, v94
  v_max_u32 v18, v18, v95
SEG_C_1:
PAD_C_5:
  s_cbranch_execz PAD_C_6
  v_cmp_eq_u32 vcc, -1, v18
  s_cbranch_vccnz L_pollBc_140
  s_bitset0_b32 s9, 3
L_pollBc_140:
  s_cmp_lg_u32 s97, 0
  s_cbranch_scc1 L_pollBf_141
  s_cmp_lg_u32 s9, 15
  s_cbranch_scc1 L_pollBg_142
  v_min_u32 v18, v80, v84
  v_min3_u32 v18, v18, v88, v92
  v_cmp_ne_u32 vcc, -1, v18
  s_cbranch_vccz L_pollBf_141
L_pollBg_142:
  s_mov_b32 s97, 1
  s_setprio 3
PAD_C_6:
  s_cbranch_execz PAD_C_7
  global_load_dwordx4 v[32:35], v[22:23], off
  v_lshl_add_u64 v[22:23], v[22:23], 0, s[60:61]
  global_load_dwordx4 v[36:39], v[22:23], off
  v_lshl_add_u64 v[22:23], v[22:23], 0, s[60:61]
  global_load_dwordx4 v[40:43], v[22:23], off
  v_lshl_add_u64 v[22:23], v[22:23], 0, s[60:61]
  global_load_dwordx4 v[44:47], v[22:23], off
PAD_C_7:
  s_cbranch_execz PAD_C_8
  v_lshl_add_u64 v[22:23], v[22:23], 0, s[60:61]
  global_load_dwordx4 v[48:51], v[22:23], off
  v_lshl_add_u64 v[22:23], v[22:23], 0, s[60:61]
  global_load_dwordx4 v[52:55], v[22:23], off
  v_lshl_add_u64 v[22:23], v[22:23], 0, s[60:61]
  global_load_dwordx4 v[56:59], v[22:23], off
  v_lshl_add_u64 v[22:23], v[22:23], 0, s[60:61]
PAD_C_8:
  s_cbranch_execz PAD_C_9
  global_load_dwordx4 v[60:63], v[22:23], off
  s_setprio 0
L_pollBf_141:
  s_cmp_eq_u32 s9, 0
  s_cbranch_scc1 L_pollBx_132
  s_branch L_pollB_131
L_pollBx_132:
  s_setprio 3
  v_add_f32 v80, v80, v84
  v_add_f32 v88, v88, v92
  v_add_f32 v81, v81, v85
  v_add_f32 v89, v89, v93
  v_add_f32 v82, v82, v86
  v_add_f32 v90, v90, v94
  v_add_f32 v83, v83, v87
  v_add_f32 v91, v91, v95
PAD_C_9:
  s_cbranch_execz WRET_C_1
  v_add_f32 v80, v80, v88
  v_add_f32 v81, v81, v89
  v_add_f32 v82, v82, v90
  v_add_f32 v83, v83, v91
  v_permlane32_swap_b32 v80, v81
  s_nop 0
  v_permlane32_swap_b32 v82, v83
  v_add_f32 v80, v80, v81
  v_add_f32 v82, v82, v83
  s_nop 1
  v_permlane16_swap_b32 v80, v82
  v_add_f32 v80, v80, v82
  v_cvt_pk_bf16_f32 v80, v80, v80
SEG_C_2:
PAD_C_10:
  s_cbranch_execz PAD_C_11
  v_and_b32 v80, 0xffff0000, v80
  v_mul_f32 v80, v26, v80
  v_cvt_pk_bf16_f32 v80, v80, v80
  v_and_b32 v80, 0xffff0000, v80
  v_add_f32 v80, v24, v80
  v_cvt_pk_bf16_f32 v80, v80, v80
  v_and_b32 v80, 0xffff0000, v80
  s_nop 0
  v_readfirstlane_b32 s20, v80
  s_nop 1
PAD_C_11:
  s_cbranch_execz PAD_C_12
  v_subrev_f32 v18, s20, v80
  v_mul_f32 v19, v18, v18
  s_nop 0
  v_add_f32_dpp v18, v18, v18 row_ror:8 row_mask:0xf bank_mask:0xf
  v_add_f32_dpp v19, v19, v19 row_ror:8 row_mask:0xf bank_mask:0xf
  s_nop 0
  v_add_f32_dpp v18, v18, v18 row_ror:4 row_mask:0xf bank_mask:0xf
  v_add_f32_dpp v19, v19, v19 row_ror:4 row_mask:0xf bank_mask:0xf
  s_nop 0
  v_add_f32_dpp v18, v18, v18 row_ror:2 row_mask:0xf bank_mask:0xf
PAD_C_12:
  s_cbranch_execz PAD_C_13
  v_add_f32_dpp v19, v19, v19 row_ror:2 row_mask:0xf bank_mask:0xf
  s_nop 0
  v_add_f32_dpp v18, v18, v18 row_ror:1 row_mask:0xf bank_mask:0xf
  v_add_f32_dpp v19, v19, v19 row_ror:1 row_mask:0xf bank_mask:0xf
  s_nop 0
  v_add_f32_dpp v18, v18, v18 row_bcast:15 row_mask:0xa bank_mask:0xf
  v_add_f32_dpp v19, v19, v19 row_bcast:15 row_mask:0xa bank_mask:0xf
  s_nop 0
  v_add_f32_dpp v18, v18, v18 row_bcast:31 row_mask:0xc bank_mask:0xf
PAD_C_13:
  s_cbranch_execz PAD_C_14
  v_add_f32_dpp v19, v19, v19 row_bcast:31 row_mask:0xc bank_mask:0xf
  v_mul_f32 v20, 0x3c800000, v18
  v_fma_f32 v19, -v20, v18, v19
  v_add_f32 v18, s20, v20
  s_lshl_b64 exec, 1, 63
  ds_write_b64 v15, v[18:19]
  s_mov_b64 exec, -1
  s_waitcnt lgkmcnt(0)
  s_barrier
  ds_read_b64 v[82:83], v3
PAD_C_14:
  s_cbranch_execz WRET_C_2
  s_waitcnt lgkmcnt(0)
  v_mov_b32 v18, v82
  s_nop 1
  v_add_f32_dpp v18, v18, v18 quad_perm:[1,0,3,2] row_mask:0xf bank_mask:0xf
  s_nop 1
  v_add_f32_dpp v18, v18, v18 quad_perm:[2,3,0,1] row_mask:0xf bank_mask:0xf
  s_nop 1
  v_add_f32_dpp v18, v18, v18 row_half_mirror row_mask:0xf bank_mask:0xf
  v_mul_f32 v18, 0x3e000000, v18
  v_sub_f32 v20, v82, v18
  v_mul_f32 v20, v20, v20
SEG_C_3:
PAD_C_15:
  s_cbranch_execz PAD_C_16
  v_fmac_f32 v83, 0x42800000, v20
  v_cvt_pk_bf16_f32 v21, v18, v18
  v_and_b32 v21, 0xffff0000, v21
  v_sub_f32 v22, v80, v21
  v_cvt_pk_bf16_f32 v22, v22, v22
  v_and_b32 v22, 0xffff0000, v22
  v_add_f32_dpp v83, v83, v83 quad_perm:[1,0,3,2] row_mask:0xf bank_mask:0xf
  s_nop 1
PAD_C_16:
  s_cbranch_execz PAD_C_17
  v_add_f32_dpp v83, v83, v83 quad_perm:[2,3,0,1] row_mask:0xf bank_mask:0xf
  s_nop 1
  v_add_f32_dpp v83, v83, v83 row_half_mirror row_mask:0xf bank_mask:0xf
  v_mul_f32 v19, 0x3b000000, v83
  v_cvt_pk_bf16_f32 v19, v19, v19
  v_and_b32 v19, 0xffff0000, v19
  v_add_f32 v19, 0x3727c5ac, v19
  v_cvt_pk_bf16_f32 v19, v19, v19
PAD_C_17:
  s_cbranch_execz PAD_C_18
  v_and_b32 v19, 0xffff0000, v19
  v_sqrt_f32 v19, v19
  s_nop 0
  v_cvt_pk_bf16_f32 v19, v19, v19
  v_and_b32 v19, 0xffff0000, v19
  v_rcp_f32 v23, v19
  s_nop 0
  v_mul_f32 v81, v22, v23
  v_fma_f32 v20, -v81, v19, v22
  v_fma_f32 v81, v20, v23, v81
PAD_C_18:
  s_cbranch_execz PAD_C_19
  v_cvt_pk_bf16_f32 v81, v81, v81
  v_and_b32 v81, 0xffff0000, v81
  v_mul_f32 v81, v81, v30
  v_cvt_pk_bf16_f32 v81, v81, v81
  v_and_b32 v81, 0xffff0000, v81
  v_add_f32 v81, v81, v28
  v_cvt_pk_bf16_f32 v18, v81, v81
  s_waitcnt vmcnt(0)
  v_mov_b32 v19, v18
  v_mov_b32 v20, v18
PAD_C_19:
  s_cbranch_execz WRET_C_3
  s_nop 0
  v_mov_b32_dpp v19, v18 row_shr:4 row_mask:0xf bank_mask:0xa
  v_mov_b32_dpp v20, v18 row_shl:4 row_mask:0xf bank_mask:0x5
  s_nop 0
  v_and_b32_dpp v84, v19, v9 quad_perm:[0,0,0,0] row_mask:0xf bank_mask:0xf
  v_and_b32_dpp v85, v19, v10 quad_perm:[0,0,0,0] row_mask:0xf bank_mask:0xf
  v_and_b32_dpp v86, v19, v11 quad_perm:[0,0,0,0] row_mask:0xf bank_mask:0xf
  v_and_b32_dpp v87, v19, v12 quad_perm:[0,0,0,0] row_mask:0xf bank_mask:0xf
SEG_C_4:
PAD_C_20:
  s_cbranch_execz PAD_C_21
  v_and_b32_dpp v88, v19, v9 quad_perm:[1,1,1,1] row_mask:0xf bank_mask:0xf
  v_and_b32_dpp v89, v19, v10 quad_perm:[1,1,1,1] row_mask:0xf bank_mask:0xf
  v_and_b32_dpp v90, v19, v11 quad_perm:[1,1,1,1] row_mask:0xf bank_mask:0xf
  v_and_b32_dpp v91, v19, v12 quad_perm:[1,1,1,1] row_mask:0xf bank_mask:0xf
  v_mfma_f32_16x16x32_bf16 v[96:99], v[84:87], v[32:35], 0
  v_and_b32_dpp v92, v19, v9 quad_perm:[2,2,2,2] row_mask:0xf bank_mask:0xf
  v_and_b32_dpp v93, v19, v10 quad_perm:[2,2,2,2] row_mask:0xf bank_mask:0xf
PAD_C_21:
  s_cbranch_execz PAD_C_22
  v_and_b32_dpp v94, v19, v11 quad_perm:[2,2,2,2] row_mask:0xf bank_mask:0xf
  v_and_b32_dpp v95, v19, v12 quad_perm:[2,2,2,2] row_mask:0xf bank_mask:0xf
  v_mfma_f32_16x16x32_bf16 v[96:99], v[88:91], v[36:39], v[96:99]
  v_and_b32_dpp v84, v19, v9 quad_perm:[3,3,3,3] row_mask:0xf bank_mask:0xf
  v_and_b32_dpp v85, v19, v10 quad_perm:[3,3,3,3] row_mask:0xf bank_mask:0xf
  v_and_b32_dpp v86, v19, v11 quad_perm:[3,3,3,3] row_mask:0xf bank_mask:0xf
  v_and_b32_dpp v87, v19, v12 quad_perm:[3,3,3,3] row_mask:0xf bank_mask:0xf
PAD_C_22:
  s_cbranch_execz PAD_C_23
  v_mfma_f32_16x16x32_bf16 v[96:99], v[92:95], v[40:43], v[96:99]
  v_and_b32_dpp v88, v20, v9 quad_perm:[0,0,0,0] row_mask:0xf bank_mask:0xf
  v_and_b32_dpp v89, v20, v10 quad_perm:[0,0,0,0] row_mask:0xf bank_mask:0xf
  v_and_b32_dpp v90, v20, v11 quad_perm:[0,0,0,0] row_mask:0xf bank_mask:0xf
  v_and_b32_dpp v91, v20, v12 quad_perm:[0,0,0,0] row_mask:0xf bank_mask:0xf
  v_mfma_f32_16x16x32_bf16 v[96:99], v[84:87], v[44:47], v[96:99]
  v_and_b32_dpp v92, v20, v9 quad_perm:[1,1,1,1] row_mask:0xf bank_mask:0xf
PAD_C_23:
  s_cbranch_execz PAD_C_24
  v_and_b32_dpp v93, v20, v10 quad_perm:[1,1,1,1] row_mask:0xf bank_mask:0xf
  v_and_b32_dpp v94, v20, v11 quad_perm:[1,1,1,1] row_mask:0xf bank_mask:0xf
  v_and_b32_dpp v95, v20, v12 quad_perm:[1,1,1,1] row_mask:0xf bank_mask:0xf
  v_mfma_f32_16x16x32_bf16 v[96:99], v[88:91], v[48:51], v[96:99]
  v_and_b32_dpp v84, v20, v9 quad_perm:[2,2,2,2] row_mask:0xf bank_mask:0xf
  v_and_b32_dpp v85, v20, v10 quad_perm:[2,2,2,2] row_mask:0xf bank_mask:0xf
  v_and_b32_dpp v86, v20, v11 quad_perm:[2,2,2,2] row_mask:0xf bank_mask:0xf
PAD_C_24:
  s_cbranch_execz WRET_C_4
  v_and_b32_dpp v87, v20, v12 quad_perm:[2,2,2,2] row_mask:0xf bank_mask:0xf
  v_mfma_f32_16x16x32_bf16 v[96:99], v[92:95], v[52:55], v[96:99]
  v_and_b32_dpp v88, v20, v9 quad_perm:[3,3,3,3] row_mask:0xf bank_mask:0xf
  v_and_b32_dpp v89, v20, v10 quad_perm:[3,3,3,3] row_mask:0xf bank_mask:0xf
  v_and_b32_dpp v90, v20, v11 quad_perm:[3,3,3,3] row_mask:0xf bank_mask:0xf
  v_and_b32_dpp v91, v20, v12 quad_perm:[3,3,3,3] row_mask:0xf bank_mask:0xf
  v_mfma_f32_16x16x32_bf16 v[96:99], v[84:87], v[56:59], v[96:99]
  s_nop 0
SEG_C_5:
PAD_C_25:
  s_cbranch_execz PAD_C_26
  v_mfma_f32_16x16x32_bf16 v[96:99], v[88:91], v[60:63], v[96:99]
  s_nop 7
  v_mov_b32 v100, v96
  v_mov_b32 v101, v97
  v_mov_b32 v102, v98
  v_mov_b32 v103, v99
  v_permlane32_swap_b32 v96, v100
  v_permlane32_swap_b32 v97, v101
  v_permlane32_swap_b32 v98, v102
  v_permlane32_swap_b32 v99, v103
  v_add_f32_dpp v96, v100, v96 row_ror:8 row_mask:0xf bank_mask:0xf
  v_add_f32_dpp v97, v101, v97 row_ror:8 row_mask:0xf bank_mask:0xf
PAD_C_26:
  s_cbranch_execz PAD_C_27
  v_add_f32_dpp v98, v102, v98 row_ror:8 row_mask:0xf bank_mask:0xf
  v_add_f32_dpp v99, v103, v99 row_ror:8 row_mask:0xf bank_mask:0xf
  s_mov_b32 exec_lo, 0x00ff00ff
  s_mov_b32 exec_hi, 0
  ds_write_b32 v27, v96 offset:0
  ds_write_b32 v27, v97 offset:32
  ds_write_b32 v27, v98 offset:64
  ds_write_b32 v27, v99 offset:96
PAD_C_27:
  s_cbranch_execz PAD_C_28
  s_mov_b64 exec, -1
  s_waitcnt lgkmcnt(0)
  s_barrier
  ds_read_b128 v[84:87], v13
  ds_read_b128 v[88:91], v13 offset:16
  ds_read_b128 v[100:103], v13 offset:1024
  ds_read_b128 v[104:107], v13 offset:1040
  s_waitcnt lgkmcnt(2)
  v_add_f32 v84, v84, v85
  v_add_f32 v86, v86, v87
  v_add_f32 v88, v88, v89
PAD_C_28:
  s_cbranch_execz PAD_C_29
  v_add_f32 v90, v90, v91
  v_add_f32 v84, v84, v86
  v_add_f32 v88, v88, v90
  v_add_f32 v84, v84, v88
  s_waitcnt lgkmcnt(0)
  v_add_f32 v100, v100, v101
  v_add_f32 v102, v102, v103
  v_add_f32 v104, v104, v105
  v_add_f32 v106, v106, v107
  v_add_f32 v100, v100, v102
  v_add_f32 v104, v104, v106
  v_add_f32 v100, v100, v104
  v_mov_b32 v85, v100
  v_cvt_pk_bf16_f32 v84, v84, v84
PAD_C_29:
  s_cbranch_execz WRET_C_5
  v_and_b32 v84, 0xffff0000, v84
  v_cvt_pk_bf16_f32 v85, v85, v85
  v_and_b32 v85, 0xffff0000, v85
  v_mul_f32 v86, v84, v84
  v_mul_f32 v86, v86, v84
  v_fma_f32 v86, v86, v7, v84
  v_mul_f32 v86, 0xc0135761, v86
  v_exp_f32 v86, v86
  s_nop 0
  v_add_f32 v86, 1.0, v86
SEG_C_6:
PAD_C_30:
  s_cbranch_execz PAD_C_31
  v_rcp_f32 v86, v86
  s_nop 0
  v_mul_f32 v86, v84, v86
  v_cvt_pk_bf16_f32 v86, v86, v86
  v_and_b32 v86, 0xffff0000, v86
  v_mul_f32 v86, v86, v85
  v_cvt_pk_bf16_f32 v18, v86, v86
  s_waitcnt vmcnt(0)
  s_nop 0
  v_and_b32_dpp v84, v18, v9 quad_perm:[0,0,0,0] row_mask:0xf bank_mask:0xf
PAD_C_31:
  s_cbranch_execz PAD_C_32
  v_and_b32_dpp v85, v18, v10 quad_perm:[0,0,0,0] row_mask:0xf bank_mask:0xf
  v_and_b32_dpp v86, v18, v11 quad_perm:[0,0,0,0] row_mask:0xf bank_mask:0xf
  v_and_b32_dpp v87, v18, v12 quad_perm:[0,0,0,0] row_mask:0xf bank_mask:0xf
  v_and_b32_dpp v88, v18, v9 quad_perm:[1,1,1,1] row_mask:0xf bank_mask:0xf
  v_and_b32_dpp v89, v18, v10 quad_perm:[1,1,1,1] row_mask:0xf bank_mask:0xf
  v_and_b32_dpp v90, v18, v11 quad_perm:[1,1,1,1] row_mask:0xf bank_mask:0xf
  v_and_b32_dpp v91, v18, v12 quad_perm:[1,1,1,1] row_mask:0xf bank_mask:0xf
PAD_C_32:
  s_cbranch_execz PAD_C_33
  v_mfma_f32_16x16x32_bf16 v[96:99], v[84:87], v[64:67], 0
  v_and_b32_dpp v92, v18, v9 quad_perm:[2,2,2,2] row_mask:0xf bank_mask:0xf
  v_and_b32_dpp v93, v18, v10 quad_perm:[2,2,2,2] row_mask:0xf bank_mask:0xf
  v_and_b32_dpp v94, v18, v11 quad_perm:[2,2,2,2] row_mask:0xf bank_mask:0xf
  v_and_b32_dpp v95, v18, v12 quad_perm:[2,2,2,2] row_mask:0xf bank_mask:0xf
  v_mfma_f32_16x16x32_bf16 v[96:99], v[88:91], v[68:71], v[96:99]
  v_and_b32_dpp v84, v18, v9 quad_perm:[3,3,3,3] row_mask:0xf bank_mask:0xf
PAD_C_33:
  s_cbranch_execz PAD_C_34
  v_and_b32_dpp v85, v18, v10 quad_perm:[3,3,3,3] row_mask:0xf bank_mask:0xf
  v_and_b32_dpp v86, v18, v11 quad_perm:[3,3,3,3] row_mask:0xf bank_mask:0xf
  v_and_b32_dpp v87, v18, v12 quad_perm:[3,3,3,3] row_mask:0xf bank_mask:0xf
  v_mfma_f32_16x16x32_bf16 v[96:99], v[92:95], v[72:75], v[96:99]
  s_nop 0
  v_mfma_f32_16x16x32_bf16 v[96:99], v[84:87], v[76:79], v[96:99]
  s_nop 7
  v_mov_b32 v100, v96
  v_mov_b32 v101, v97
  v_mov_b32 v102, v98
PAD_C_34:
  s_cbranch_execz WRET_C_6
  v_mov_b32 v103, v99
  v_permlane32_swap_b32 v96, v100
  v_permlane32_swap_b32 v97, v101
  v_permlane32_swap_b32 v98, v102
  v_permlane32_swap_b32 v99, v103
  v_add_f32_dpp v96, v100, v96 row_ror:8 row_mask:0xf bank_mask:0xf
  v_add_f32_dpp v97, v101, v97 row_ror:8 row_mask:0xf bank_mask:0xf
  v_add_f32_dpp v98, v102, v98 row_ror:8 row_mask:0xf bank_mask:0xf
  v_add_f32_dpp v99, v103, v99 row_ror:8 row_mask:0xf bank_mask:0xf
  v_min_u32 v96, -2, v96
  v_min_u32 v97, -2, v97
SEG_C_7:
PAD_C_35:
  s_cbranch_execz PAD_C_36
  v_min_u32 v98, -2, v98
  v_min_u32 v99, -2, v99
  s_mov_b32 exec_lo, 0x00ff00ff
  s_mov_b32 exec_hi, 0
  buffer_store_dwordx4 v[96:99], v14, s[56:59], s23 offen sc1
  s_mov_b64 exec, -1
PAD_C_36:
  s_cbranch_execz WRET_C_7
L_Rend_64:
  s_endpgm
L_end:
  s_endpgm

.section .rodata,"a"
.p2align 6
.amdhsa_kernel adaLN_cond__gqa_block_cached__glu_gated_geglu__decode_kernel
  .amdhsa_next_free_vgpr 128
  .amdhsa_next_free_sgpr 102
  .amdhsa_accum_offset 128
  .amdhsa_group_segment_fixed_size 0
  .amdhsa_kernarg_size 112
  .amdhsa_user_sgpr_count 2
  .amdhsa_user_sgpr_kernarg_segment_ptr 1
  .amdhsa_system_sgpr_workgroup_id_x 1
  .amdhsa_float_denorm_mode_32 3
.end_amdhsa_kernel
```
